```python
import torch

def _softmax(x, axis=-1):
    return torch.softmax(x, dim=axis)
def _gelu(x):
    return torch.nn.functional.gelu(x, approximate="tanh")
def _silu(x):
    return torch.nn.functional.silu(x)
def _sigmoid(x):
    return torch.sigmoid(x)
def _layernorm(x, axis=-1, eps=1e-5):
    m = x.mean(dim=axis, keepdim=True)
    v = x.var(dim=axis, keepdim=True, unbiased=False)
    return (x - m) / torch.sqrt(v + eps)
def _scatter_add(tgt, idx, src, axis=0):
    return tgt.clone().index_add_(axis, idx, src)
def _segment_sum(src, seg, n):
    out = torch.zeros((n,) + src.shape[1:], dtype=src.dtype)
    return out.index_add_(0, seg, src)
def _pad(x, pw):
    flat = tuple(v for pair in reversed(pw) for v in pair)
    return torch.nn.functional.pad(x, flat)

kernel_name = 'standalone__gqa_block_cached__near_ridge'

def setup_inputs():

    _w = (lambda a: (lambda t: t.to(torch.bfloat16) if t.is_floating_point() else t)(torch.as_tensor(a)))
    B, Sq, D = 8, 160, 448
    Hq, Hkv, Sk, Dh = 16, 8, 1024, 256
    assert Hq % Hkv == 0, (Hq, Hkv)
    return {
        "x": _w((lambda *s: torch.randn(*s, dtype=torch.bfloat16) * 0.8)(B, Sq, D)),
        "k_cache": _w((lambda *s: torch.randn(*s, dtype=torch.bfloat16) * 0.8)(B, Hkv, Sk, Dh)),
        "v_cache": _w((lambda *s: torch.randn(*s, dtype=torch.bfloat16) * 0.05)(B, Hkv, Sk, Dh)),
        "wq": _w((lambda *s: torch.randn(*s, dtype=torch.bfloat16) * 0.8)(D, Hq * Dh) * (D ** -0.5)),
        "wo": _w((lambda *s: torch.randn(*s, dtype=torch.bfloat16) * 0.05)(Hq * Dh, D) * ((Hq * Dh) ** -0.5)),
    }

def reference(x, k_cache, v_cache, wq, wo):
    B, Sq, D = x.shape
    Hq, Dh = 16, 256
    Hkv = k_cache.shape[1]
    rep = Hq // Hkv
    q = (lambda x, *d: x.permute(*d))((x @ wq).reshape(B, Sq, Hq, Dh), 0, 2, 1, 3)
    k = (lambda x, n, axis: torch.repeat_interleave(x, n, dim=axis))(k_cache, rep, axis=1)
    v = (lambda x, n, axis: torch.repeat_interleave(x, n, dim=axis))(v_cache, rep, axis=1)
    scores = torch.einsum("bhqd,bhkd->bhqk", q, k) * (Dh ** -0.5)
    p = _softmax(scores, axis=-1)
    o = torch.einsum("bhqk,bhkd->bhqd", p, v)
    return (lambda x, *d: x.permute(*d))(o, 0, 2, 1, 3).reshape(B, Sq, Hq * Dh) @ wo
```

```asm
; @launch grid=(256,1,1) block=(512,1,1) lds=163840
.amdgcn_target "amdgcn-amd-amdhsa--gfx950"
.text
.globl standalone__gqa_block_cached__near_ridge_kernel
.p2align 8
.type standalone__gqa_block_cached__near_ridge_kernel,@function
standalone__gqa_block_cached__near_ridge_kernel:
    s_cmp_ge_u32 s2, 256
    s_cbranch_scc1 L_end
    s_load_dwordx16 s[4:19], s[0:1], 0
    v_and_b32 v1, 63, v0
    v_lshrrev_b32 v2, 6, v0
    s_nop 0
    v_readfirstlane_b32 s20, v2
    s_and_b32 s23, s2, 7
    s_lshr_b32 s22, s2, 5
    s_bfe_u32 s26, s2, 0x10004
    s_bfe_u32 s27, s2, 0x10003
    s_lshl_b32 s24, s23, 1
    s_add_u32 s24, s24, s26
    s_lshl_b32 s25, s22, 1
    s_add_u32 s25, s25, s27
    s_and_b32 s21, s20, 3
    s_cmp_ge_u32 s20, 4
    s_cbranch_scc1 L_pv
    v_lshrrev_b32 v104, 3, v1
    v_and_b32 v104, 2, v104
    v_and_b32 v105, 7, v1
    v_xor_b32 v104, v104, v105
    v_lshlrev_b32 v104, 4, v104
    v_lshrrev_b32 v105, 3, v1
    v_mul_u32_u24 v105, 8192, v105
    v_add_u32 v100, v104, v105
    v_xor_b32 v104, 64, v104
    v_add_u32 v101, v104, v105
    v_add_u32 v101, 64512, v101
    v_lshrrev_b32 v105, 3, v1
    v_and_b32 v104, 7, v1
    v_xor_b32 v104, v104, v105
    v_lshlrev_b32 v104, 4, v104
    v_mul_u32_u24 v105, 896, v105
    v_add_u32 v102, v104, v105
    v_add_u32 v103, 7168, v102
    s_and_b32 s26, s21, 1
    s_cmp_eq_u32 s26, 1
    s_cselect_b64 vcc, -1, 0
    v_cndmask_b32 v102, v102, v103, vcc
    s_add_u32 s26, s25, s24
    s_mul_i32 s27, s26, 37
    s_lshr_b32 s27, s27, 8
    s_mul_i32 s27, s27, 7
    s_sub_u32 s56, s26, s27
    s_lshl_b32 s28, s56, 7
    s_add_u32 s26, s21, 0
    s_lshl_b32 s59, s26, 10
    s_lshr_b32 s26, s26, 1
    s_mul_i32 s62, s26, 14336
    s_add_u32 s62, s62, s28
    s_add_u32 s26, s21, 4
    s_lshl_b32 s60, s26, 10
    s_lshr_b32 s26, s26, 1
    s_mul_i32 s63, s26, 14336
    s_add_u32 s63, s63, s28
    s_add_u32 s26, s21, 8
    s_add_u32 s27, s21, 4
    s_cmp_ge_u32 s26, 10
    s_cselect_b32 s26, s27, s26
    s_lshl_b32 s61, s26, 10
    s_lshr_b32 s26, s26, 1
    s_mul_i32 s64, s26, 14336
    s_add_u32 s64, s64, s28
    s_lshl_b32 s71, s21, 7
    s_lshl_b32 s26, s56, 19
    s_add_u32 s71, s71, s26
    s_lshl_b32 s55, s21, 13
    s_lshl_b32 s26, s24, 9
    s_sub_u32 s27, 3670016, s26
    s_mul_i32 s28, s25, 71680
    s_waitcnt lgkmcnt(0)
    s_add_u32 s36, s10, s26
    s_addc_u32 s37, s11, 0
    s_mov_b32 s38, s27
    s_mov_b32 s39, 0x20000
    s_add_u32 s40, s4, s28
    s_addc_u32 s41, s5, 0
    s_mov_b32 s42, 71680
    s_mov_b32 s43, 0x20000
    s_add_u32 m0, s59, 131072
    s_nop 0
    buffer_load_dwordx4 v102, s[40:43], s62 offen lds
    s_add_u32 s62, s62, 128
    s_add_u32 m0, s60, 131072
    s_nop 0
    buffer_load_dwordx4 v102, s[40:43], s63 offen lds
    s_add_u32 s63, s63, 128
    s_add_u32 m0, s61, 131072
    s_nop 0
    buffer_load_dwordx4 v102, s[40:43], s64 offen lds
    s_add_u32 s64, s64, 128
    s_add_u32 m0, s55, 98304
    s_nop 0
    buffer_load_dwordx4 v100, s[36:39], s71 offen lds
    buffer_load_dwordx4 v101, s[36:39], s71 offen offset:1024 lds
    s_add_u32 s71, s71, 131072
    s_add_u32 m0, s55, 100352
    s_nop 0
    buffer_load_dwordx4 v100, s[36:39], s71 offen lds
    buffer_load_dwordx4 v101, s[36:39], s71 offen offset:1024 lds
    s_add_u32 s71, s71, 131072
    s_add_u32 m0, s55, 102400
    s_nop 0
    buffer_load_dwordx4 v100, s[36:39], s71 offen lds
    buffer_load_dwordx4 v101, s[36:39], s71 offen offset:1024 lds
    s_add_u32 s71, s71, 131072
    s_add_u32 m0, s55, 104448
    s_nop 0
    buffer_load_dwordx4 v100, s[36:39], s71 offen lds
    buffer_load_dwordx4 v101, s[36:39], s71 offen offset:1024 lds
    s_add_u32 s71, s71, 131072
    s_add_u32 s56, s56, 1
    s_cmp_eq_u32 s56, 7
    s_cselect_b32 s88, 3670016, 0
    s_cselect_b32 s89, 896, 0
    s_sub_u32 s71, s71, s88
    s_sub_u32 s62, s62, s89
    s_sub_u32 s63, s63, s89
    s_sub_u32 s64, s64, s89
    s_mul_i32 s26, s24, 229376
    s_add_u32 s44, s12, s26
    s_addc_u32 s45, s13, 0
    s_mov_b32 s46, 229376
    s_mov_b32 s47, 0x20000
    s_lshl_b32 s26, s25, 4
    s_add_u32 s26, s26, s24
    s_mul_i32 s26, s26, 71680
    s_add_u32 s48, s18, s26
    s_addc_u32 s49, s19, 0
    s_mov_b32 s50, 71680
    s_mov_b32 s51, 0x20000
    s_mul_i32 s26, s25, 4352
    s_add_u32 s26, s26, 67108864
    s_add_u32 s92, s18, s26
    s_addc_u32 s93, s19, 0
    s_mov_b32 s94, 128
    s_mov_b32 s95, 0x20000
    s_lshl_b32 s26, s22, 3
    s_add_u32 s26, s26, s23
    s_lshl_b32 s28, s26, 19
    s_add_u32 s32, s6, s28
    s_addc_u32 s33, s7, 0
    s_mov_b32 s34, 524288
    s_mov_b32 s35, 0x20000
    s_add_u32 s84, s8, s28
    s_addc_u32 s85, s9, 0
    s_mov_b32 s86, 524288
    s_mov_b32 s87, 0x20000
    s_mov_b32 s58, s21
    v_lshrrev_b32 v7, 3, v1
    v_and_b32 v6, 7, v1
    v_xor_b32 v6, v6, v7
    v_lshlrev_b32 v6, 4, v6
    v_mul_u32_u24 v7, 512, v7
    v_add_u32 v8, v6, v7
    v_add_u32 v9, 3072, v8
    v_lshrrev_b32 v104, 3, v1
    v_and_b32 v104, 2, v104
    v_and_b32 v105, 7, v1
    v_xor_b32 v104, v104, v105
    v_lshlrev_b32 v104, 4, v104
    v_lshrrev_b32 v105, 3, v1
    v_mul_u32_u24 v105, 512, v105
    v_add_u32 v92, v104, v105
    v_xor_b32 v104, 64, v104
    v_add_u32 v93, v104, v105
    v_add_u32 v93, 3072, v93
    s_lshl_b32 s57, s21, 13
    s_bfe_u32 s26, s2, 0x40003
    s_mov_b32 s90, 0x76543210
    s_mov_b32 s91, 0xfedcba98
    s_cmp_eq_u32 s26, 1
    s_cselect_b32 s90, 0x87354021, s90
    s_cselect_b32 s91, 0xfced9ba6, s91
    s_cmp_eq_u32 s26, 2
    s_cselect_b32 s90, 0x68435102, s90
    s_cselect_b32 s91, 0xfdcea9b7, s91
    s_cmp_eq_u32 s26, 3
    s_cselect_b32 s90, 0x68354210, s90
    s_cselect_b32 s91, 0xfcedba97, s91
    s_cmp_eq_u32 s26, 4
    s_cselect_b32 s90, 0x87654321, s90
    s_cselect_b32 s91, 0xfedcba9, s91
    s_cmp_eq_u32 s26, 5
    s_cselect_b32 s90, 0x68735402, s90
    s_cselect_b32 s91, 0x1fced9ba, s91
    s_cmp_eq_u32 s26, 6
    s_cselect_b32 s90, 0x76843510, s90
    s_cselect_b32 s91, 0x2fdcea9b, s91
    s_cmp_eq_u32 s26, 7
    s_cselect_b32 s90, 0x76835421, s90
    s_cselect_b32 s91, 0xfcedba9, s91
    s_cmp_eq_u32 s26, 8
    s_cselect_b32 s90, 0x98765432, s90
    s_cselect_b32 s91, 0x10fedcba, s91
    s_cmp_eq_u32 s26, 9
    s_cselect_b32 s90, 0xa6873540, s90
    s_cselect_b32 s91, 0x21fced9b, s91
    s_cmp_eq_u32 s26, 10
    s_cselect_b32 s90, 0xb7684351, s90
    s_cselect_b32 s91, 0x2fdcea9, s91
    s_cmp_eq_u32 s26, 11
    s_cselect_b32 s90, 0x97683542, s90
    s_cselect_b32 s91, 0x10fcedba, s91
    s_cmp_eq_u32 s26, 13
    s_cselect_b32 s90, 0x87354021, s90
    s_cselect_b32 s91, 0xfced9ba6, s91
    s_cmp_eq_u32 s26, 14
    s_cselect_b32 s90, 0x68435102, s90
    s_cselect_b32 s91, 0xfdcea9b7, s91
    s_cmp_eq_u32 s26, 15
    s_cselect_b32 s90, 0x68354210, s90
    s_cselect_b32 s91, 0xfcedba97, s91
    s_mov_b32 s54, 32768
    s_and_b32 s83, s90, 15
    s_lshl_b32 s83, s83, 15
    s_lshl_b32 s26, s21, 7
    s_add_u32 s83, s83, s26
    s_and_b32 s52, s90, 15
    s_lshr_b64 s[90:91], s[90:91], 4
    s_mul_i32 s52, s52, s54
    s_add_u32 s52, s52, s57
    s_mov_b32 s53, 128
    v_and_b32 v6, 15, v1
    v_and_b32 v7, 7, v1
    v_lshlrev_b32 v6, 7, v6
    v_lshrrev_b32 v4, 5, v1
    v_xor_b32 v7, v7, v4
    v_lshlrev_b32 v7, 4, v7
    v_add_u32 v6, v6, v7
    s_lshl_b32 s26, s21, 5
    v_xor_b32 v6, s26, v6
    v_add_u32 v6, 131072, v6
    v_bfe_u32 v7, v1, 4, 1
    v_lshl_add_u32 v4, v7, 3, v6
    v_lshl_add_u32 v10, v7, 11, v6
    v_mov_b32 v5, 155648
    v_mov_b32 v11, 0
    v_mov_b32 v20, 0
    v_mov_b32 v21, 0
    v_mov_b32 v22, 0
    v_mov_b32 v23, 0
    v_mov_b32 v12, 0
    v_mov_b32 v24, 0
    v_mov_b32 v25, 0
    v_mov_b32 v26, 0
    v_mov_b32 v27, 0
    v_mov_b32 v13, 0
    v_mov_b32 v28, 0
    v_mov_b32 v29, 0
    v_mov_b32 v30, 0
    v_mov_b32 v31, 0
    v_mov_b32 v14, 0
    v_mov_b32 v32, 0
    v_mov_b32 v33, 0
    v_mov_b32 v34, 0
    v_mov_b32 v35, 0
    v_mov_b32 v15, 0
    v_mov_b32 v36, 0
    v_mov_b32 v37, 0
    v_mov_b32 v38, 0
    v_mov_b32 v39, 0
    v_and_b32 v6, 15, v1
    v_and_b32 v7, 7, v1
    v_lshlrev_b32 v6, 7, v6
    v_lshrrev_b32 v2, 4, v1
    v_xor_b32 v7, v7, v2
    v_lshlrev_b32 v7, 4, v7
    v_add_u32 v2, v6, v7
    v_xor_b32 v3, 64, v2
    v_add_u32 v6, 98304, v2
    v_add_u32 v2, s55, v2
    v_add_u32 v7, 98304, v3
    v_add_u32 v3, s55, v3
    s_add_u32 m0, s59, 141312
    s_nop 0
    buffer_load_dwordx4 v102, s[40:43], s62 offen lds
    s_add_u32 s62, s62, 128
    s_add_u32 m0, s60, 141312
    s_nop 0
    buffer_load_dwordx4 v102, s[40:43], s63 offen lds
    s_add_u32 s63, s63, 128
    s_add_u32 m0, s61, 141312
    s_nop 0
    buffer_load_dwordx4 v102, s[40:43], s64 offen lds
    s_add_u32 s64, s64, 128
    s_add_u32 m0, s55, 65536
    s_nop 0
    buffer_load_dwordx4 v100, s[36:39], s71 offen lds
    buffer_load_dwordx4 v101, s[36:39], s71 offen offset:1024 lds
    s_add_u32 s71, s71, 131072
    s_add_u32 m0, s55, 67584
    s_nop 0
    buffer_load_dwordx4 v100, s[36:39], s71 offen lds
    buffer_load_dwordx4 v101, s[36:39], s71 offen offset:1024 lds
    s_add_u32 s71, s71, 131072
    s_add_u32 m0, s55, 69632
    s_nop 0
    buffer_load_dwordx4 v100, s[36:39], s71 offen lds
    buffer_load_dwordx4 v101, s[36:39], s71 offen offset:1024 lds
    s_add_u32 s71, s71, 131072
    s_add_u32 m0, s55, 71680
    s_nop 0
    buffer_load_dwordx4 v100, s[36:39], s71 offen lds
    buffer_load_dwordx4 v101, s[36:39], s71 offen offset:1024 lds
    s_add_u32 s71, s71, 131072
    s_add_u32 s56, s56, 1
    s_cmp_eq_u32 s56, 7
    s_cselect_b32 s88, 3670016, 0
    s_cselect_b32 s89, 896, 0
    s_sub_u32 s71, s71, s88
    s_sub_u32 s62, s62, s89
    s_sub_u32 s63, s63, s89
    s_sub_u32 s64, s64, s89
    s_waitcnt vmcnt(11)
    s_barrier
    s_add_u32 m0, s59, 151552
    s_nop 0
    buffer_load_dwordx4 v102, s[40:43], s62 offen lds
    s_add_u32 s62, s62, 128
    s_add_u32 m0, s60, 151552
    s_nop 0
    buffer_load_dwordx4 v102, s[40:43], s63 offen lds
    s_add_u32 s63, s63, 128
    s_add_u32 m0, s61, 151552
    s_nop 0
    buffer_load_dwordx4 v102, s[40:43], s64 offen lds
    s_add_u32 s64, s64, 128
    s_add_u32 m0, s55, 32768
    s_nop 0
    buffer_load_dwordx4 v100, s[36:39], s71 offen lds
    buffer_load_dwordx4 v101, s[36:39], s71 offen offset:1024 lds
    s_add_u32 s71, s71, 131072
    s_add_u32 m0, s55, 34816
    s_nop 0
    buffer_load_dwordx4 v100, s[36:39], s71 offen lds
    buffer_load_dwordx4 v101, s[36:39], s71 offen offset:1024 lds
    s_add_u32 s71, s71, 131072
    s_add_u32 m0, s55, 36864
    s_nop 0
    buffer_load_dwordx4 v100, s[36:39], s71 offen lds
    buffer_load_dwordx4 v101, s[36:39], s71 offen offset:1024 lds
    s_add_u32 s71, s71, 131072
    s_add_u32 m0, s55, 38912
    s_nop 0
    buffer_load_dwordx4 v100, s[36:39], s71 offen lds
    buffer_load_dwordx4 v101, s[36:39], s71 offen offset:1024 lds
    s_add_u32 s71, s71, 131072
    s_add_u32 s56, s56, 1
    s_cmp_eq_u32 s56, 7
    s_cselect_b32 s88, 3670016, 0
    s_cselect_b32 s89, 896, 0
    s_sub_u32 s71, s71, s88
    s_sub_u32 s62, s62, s89
    s_sub_u32 s63, s63, s89
    s_sub_u32 s64, s64, s89
    s_waitcnt vmcnt(11)
    s_barrier
    s_add_u32 m0, s59, 131072
    s_nop 0
    buffer_load_dwordx4 v102, s[40:43], s62 offen lds
    s_add_u32 s62, s62, 128
    s_add_u32 m0, s60, 131072
    s_nop 0
    buffer_load_dwordx4 v102, s[40:43], s63 offen lds
    s_add_u32 s63, s63, 128
    s_add_u32 m0, s61, 131072
    s_nop 0
    buffer_load_dwordx4 v102, s[40:43], s64 offen lds
    s_add_u32 s64, s64, 128
    s_add_u32 m0, s55, 98304
    s_nop 0
    buffer_load_dwordx4 v100, s[36:39], s71 offen lds
    buffer_load_dwordx4 v101, s[36:39], s71 offen offset:1024 lds
    s_add_u32 s71, s71, 131072
    s_add_u32 m0, s55, 100352
    s_nop 0
    buffer_load_dwordx4 v100, s[36:39], s71 offen lds
    buffer_load_dwordx4 v101, s[36:39], s71 offen offset:1024 lds
    s_add_u32 s71, s71, 131072
    s_add_u32 m0, s55, 102400
    s_nop 0
    buffer_load_dwordx4 v100, s[36:39], s71 offen lds
    buffer_load_dwordx4 v101, s[36:39], s71 offen offset:1024 lds
    s_add_u32 s71, s71, 131072
    s_add_u32 m0, s55, 104448
    s_nop 0
    buffer_load_dwordx4 v100, s[36:39], s71 offen lds
    buffer_load_dwordx4 v101, s[36:39], s71 offen offset:1024 lds
    s_add_u32 s71, s71, 131072
    s_add_u32 s56, s56, 1
    s_cmp_eq_u32 s56, 7
    s_cselect_b32 s88, 3670016, 0
    s_cselect_b32 s89, 896, 0
    s_sub_u32 s71, s71, s88
    s_sub_u32 s62, s62, s89
    s_sub_u32 s63, s63, s89
    s_sub_u32 s64, s64, s89
    s_waitcnt vmcnt(11)
    s_barrier
    s_add_u32 m0, s59, 141312
    s_nop 0
    buffer_load_dwordx4 v102, s[40:43], s62 offen lds
    s_add_u32 s62, s62, 128
    s_add_u32 m0, s60, 141312
    s_nop 0
    buffer_load_dwordx4 v102, s[40:43], s63 offen lds
    s_add_u32 s63, s63, 128
    s_add_u32 m0, s61, 141312
    s_nop 0
    buffer_load_dwordx4 v102, s[40:43], s64 offen lds
    s_add_u32 s64, s64, 128
    s_add_u32 m0, s55, 65536
    s_nop 0
    buffer_load_dwordx4 v100, s[36:39], s71 offen lds
    buffer_load_dwordx4 v101, s[36:39], s71 offen offset:1024 lds
    s_add_u32 s71, s71, 131072
    s_add_u32 m0, s55, 67584
    s_nop 0
    buffer_load_dwordx4 v100, s[36:39], s71 offen lds
    buffer_load_dwordx4 v101, s[36:39], s71 offen offset:1024 lds
    s_add_u32 s71, s71, 131072
    s_add_u32 m0, s55, 69632
    s_nop 0
    buffer_load_dwordx4 v100, s[36:39], s71 offen lds
    buffer_load_dwordx4 v101, s[36:39], s71 offen offset:1024 lds
    s_add_u32 s71, s71, 131072
    s_add_u32 m0, s55, 71680
    s_nop 0
    buffer_load_dwordx4 v100, s[36:39], s71 offen lds
    buffer_load_dwordx4 v101, s[36:39], s71 offen offset:1024 lds
    s_add_u32 s71, s71, 131072
    s_add_u32 s56, s56, 1
    s_cmp_eq_u32 s56, 7
    s_cselect_b32 s88, 3670016, 0
    s_cselect_b32 s89, 896, 0
    s_sub_u32 s71, s71, s88
    s_sub_u32 s62, s62, s89
    s_sub_u32 s63, s63, s89
    s_sub_u32 s64, s64, s89
    s_waitcnt vmcnt(11)
    s_barrier
    s_add_u32 m0, s59, 151552
    s_nop 0
    buffer_load_dwordx4 v102, s[40:43], s62 offen lds
    s_add_u32 s62, s62, 128
    s_add_u32 m0, s60, 151552
    s_nop 0
    buffer_load_dwordx4 v102, s[40:43], s63 offen lds
    s_add_u32 s63, s63, 128
    s_add_u32 m0, s61, 151552
    s_nop 0
    buffer_load_dwordx4 v102, s[40:43], s64 offen lds
    s_add_u32 s64, s64, 128
    s_add_u32 m0, s55, 32768
    s_nop 0
    buffer_load_dwordx4 v100, s[36:39], s71 offen lds
    buffer_load_dwordx4 v101, s[36:39], s71 offen offset:1024 lds
    s_add_u32 s71, s71, 131072
    s_add_u32 m0, s55, 34816
    s_nop 0
    buffer_load_dwordx4 v100, s[36:39], s71 offen lds
    buffer_load_dwordx4 v101, s[36:39], s71 offen offset:1024 lds
    s_add_u32 s71, s71, 131072
    s_add_u32 m0, s55, 36864
    s_nop 0
    buffer_load_dwordx4 v100, s[36:39], s71 offen lds
    buffer_load_dwordx4 v101, s[36:39], s71 offen offset:1024 lds
    s_add_u32 s71, s71, 131072
    s_add_u32 m0, s55, 38912
    s_nop 0
    buffer_load_dwordx4 v100, s[36:39], s71 offen lds
    buffer_load_dwordx4 v101, s[36:39], s71 offen offset:1024 lds
    s_add_u32 s71, s71, 131072
    s_add_u32 s56, s56, 1
    s_cmp_eq_u32 s56, 7
    s_cselect_b32 s88, 3670016, 0
    s_cselect_b32 s89, 896, 0
    s_sub_u32 s71, s71, s88
    s_sub_u32 s62, s62, s89
    s_sub_u32 s63, s63, s89
    s_sub_u32 s64, s64, s89
    s_waitcnt vmcnt(11)
    s_barrier
    s_add_u32 m0, s59, 131072
    s_nop 0
    buffer_load_dwordx4 v102, s[40:43], s62 offen lds
    s_add_u32 s62, s62, 128
    s_add_u32 m0, s60, 131072
    s_nop 0
    buffer_load_dwordx4 v102, s[40:43], s63 offen lds
    s_add_u32 s63, s63, 128
    s_add_u32 m0, s61, 131072
    s_nop 0
    buffer_load_dwordx4 v102, s[40:43], s64 offen lds
    s_add_u32 s64, s64, 128
    s_add_u32 m0, s55, 98304
    s_nop 0
    buffer_load_dwordx4 v100, s[36:39], s71 offen lds
    buffer_load_dwordx4 v101, s[36:39], s71 offen offset:1024 lds
    s_add_u32 s71, s71, 131072
    s_add_u32 m0, s55, 100352
    s_nop 0
    buffer_load_dwordx4 v100, s[36:39], s71 offen lds
    buffer_load_dwordx4 v101, s[36:39], s71 offen offset:1024 lds
    s_add_u32 s71, s71, 131072
    s_add_u32 m0, s55, 102400
    s_nop 0
    buffer_load_dwordx4 v100, s[36:39], s71 offen lds
    buffer_load_dwordx4 v101, s[36:39], s71 offen offset:1024 lds
    s_add_u32 s71, s71, 131072
    s_add_u32 m0, s55, 104448
    s_nop 0
    buffer_load_dwordx4 v100, s[36:39], s71 offen lds
    buffer_load_dwordx4 v101, s[36:39], s71 offen offset:1024 lds
    s_add_u32 s71, s71, 131072
    s_waitcnt vmcnt(11)
    s_barrier
    s_add_u32 m0, s55, 0
    s_nop 0
    buffer_load_dwordx4 v8, s[32:35], s52 offen lds
    buffer_load_dwordx4 v9, s[32:35], s52 offen offset:1024 lds
    s_add_u32 s52, s52, s53
    s_add_u32 m0, s55, 2048
    s_nop 0
    buffer_load_dwordx4 v8, s[32:35], s52 offen lds
    buffer_load_dwordx4 v9, s[32:35], s52 offen offset:1024 lds
    s_add_u32 s52, s52, s53
    s_add_u32 m0, s55, 4096
    s_nop 0
    buffer_load_dwordx4 v8, s[32:35], s52 offen lds
    buffer_load_dwordx4 v9, s[32:35], s52 offen offset:1024 lds
    s_add_u32 s52, s52, s53
    s_add_u32 m0, s55, 6144
    s_nop 0
    buffer_load_dwordx4 v8, s[32:35], s52 offen lds
    buffer_load_dwordx4 v9, s[32:35], s52 offen offset:1024 lds
    s_and_b32 s52, s90, 15
    s_lshr_b64 s[90:91], s[90:91], 4
    s_mul_i32 s52, s52, s54
    s_add_u32 s52, s52, s57
    s_waitcnt vmcnt(8)
    s_barrier
    s_barrier
    s_add_u32 m0, s55, 32768
    s_nop 0
    buffer_load_dwordx4 v8, s[32:35], s52 offen lds
    buffer_load_dwordx4 v9, s[32:35], s52 offen offset:1024 lds
    s_add_u32 s52, s52, s53
    s_add_u32 m0, s55, 34816
    s_nop 0
    buffer_load_dwordx4 v8, s[32:35], s52 offen lds
    buffer_load_dwordx4 v9, s[32:35], s52 offen offset:1024 lds
    s_add_u32 s52, s52, s53
    s_add_u32 m0, s55, 36864
    s_nop 0
    buffer_load_dwordx4 v8, s[32:35], s52 offen lds
    buffer_load_dwordx4 v9, s[32:35], s52 offen offset:1024 lds
    s_add_u32 s52, s52, s53
    s_add_u32 m0, s55, 38912
    s_nop 0
    buffer_load_dwordx4 v8, s[32:35], s52 offen lds
    buffer_load_dwordx4 v9, s[32:35], s52 offen offset:1024 lds
    s_and_b32 s52, s90, 15
    s_lshr_b64 s[90:91], s[90:91], 4
    s_mul_i32 s52, s52, s54
    s_add_u32 s52, s52, s57
    s_add_u32 m0, s55, 65536
    s_nop 0
    buffer_load_dwordx4 v92, s[84:87], s83 offen lds
    buffer_load_dwordx4 v93, s[84:87], s83 offen offset:1024 lds
    s_add_u32 s83, s83, 8192
    s_add_u32 m0, s55, 67584
    s_nop 0
    buffer_load_dwordx4 v92, s[84:87], s83 offen lds
    buffer_load_dwordx4 v93, s[84:87], s83 offen offset:1024 lds
    s_add_u32 s83, s83, 8192
    s_add_u32 m0, s55, 69632
    s_nop 0
    buffer_load_dwordx4 v92, s[84:87], s83 offen lds
    buffer_load_dwordx4 v93, s[84:87], s83 offen offset:1024 lds
    s_add_u32 s83, s83, 8192
    s_add_u32 m0, s55, 71680
    s_nop 0
    buffer_load_dwordx4 v92, s[84:87], s83 offen lds
    buffer_load_dwordx4 v93, s[84:87], s83 offen offset:1024 lds
    s_add_u32 s83, s83, 8192
    s_waitcnt vmcnt(22)
    ds_read_b128 v[40:43], v2 offset:0
    ds_read_b128 v[44:47], v3 offset:0
    s_waitcnt lgkmcnt(0)
    s_mov_b32 s56, 0
    s_barrier
    ds_read_b128 v[96:99], v6 offset:0
    ds_read_b128 v[128:131], v6 offset:8192
    ds_read_b128 v[160:163], v6 offset:16384
    ds_read_b128 v[192:195], v6 offset:24576
    ds_read_b128 v[224:227], v6 offset:32768
    ds_read_b128 v[100:103], v7 offset:0
    ds_read_b128 v[132:135], v7 offset:8192
    ds_read_b128 v[164:167], v7 offset:16384
    ds_read_b128 v[196:199], v7 offset:24576
    ds_read_b128 v[228:231], v7 offset:32768
    s_waitcnt lgkmcnt(9)
    v_mfma_f32_16x16x32_bf16 v[56:59], v[40:43], v[96:99], v[20:23]
    s_waitcnt vmcnt(20)
    ds_read_b128 v[48:51], v2 offset:2048
    ds_read_b128 v[104:107], v6 offset:2048
    ds_read_b128 v[136:139], v6 offset:10240
    s_waitcnt lgkmcnt(11)
    v_mfma_f32_16x16x32_bf16 v[60:63], v[40:43], v[128:131], v[24:27]
    ds_read_b128 v[52:55], v3 offset:2048
    ds_read_b128 v[168:171], v6 offset:18432
    s_waitcnt lgkmcnt(12)
    v_mfma_f32_16x16x32_bf16 v[64:67], v[40:43], v[160:163], v[28:31]
    s_add_u32 m0, s55, 0
    ds_read_b128 v[200:203], v6 offset:26624
    ds_read_b128 v[232:235], v6 offset:34816
    s_waitcnt lgkmcnt(13)
    v_mfma_f32_16x16x32_bf16 v[68:71], v[40:43], v[192:195], v[32:35]
    buffer_load_dwordx4 v8, s[32:35], s52 offen lds
    ds_read_b128 v[108:111], v7 offset:2048
    s_waitcnt lgkmcnt(13)
    v_mfma_f32_16x16x32_bf16 v[72:75], v[40:43], v[224:227], v[36:39]
    ds_read_b128 v[140:143], v7 offset:10240
    ds_read_b128 v[172:175], v7 offset:18432
    s_waitcnt lgkmcnt(14)
    v_mfma_f32_16x16x32_bf16 v[56:59], v[44:47], v[100:103], v[56:59]
    s_waitcnt vmcnt(19)
    ds_read_b128 v[40:43], v2 offset:4096
    s_waitcnt lgkmcnt(14)
    ds_read_b128 v[204:207], v7 offset:26624
    v_mfma_f32_16x16x32_bf16 v[60:63], v[44:47], v[132:135], v[60:63]
    s_waitcnt lgkmcnt(14)
    ds_read_b128 v[236:239], v7 offset:34816
    s_waitcnt lgkmcnt(14)
    ds_read_b128 v[112:115], v6 offset:4096
    v_mfma_f32_16x16x32_bf16 v[64:67], v[44:47], v[164:167], v[64:67]
    s_waitcnt lgkmcnt(14)
    ds_read_b128 v[144:147], v6 offset:12288
    v_mfma_f32_16x16x32_bf16 v[68:71], v[44:47], v[196:199], v[68:71]
    buffer_load_dwordx4 v9, s[32:35], s52 offen offset:1024 lds
    s_add_u32 s52, s52, s53
    s_waitcnt lgkmcnt(14)
    ds_read_b128 v[176:179], v6 offset:20480
    s_waitcnt lgkmcnt(14)
    ds_read_b128 v[208:211], v6 offset:28672
    v_mfma_f32_16x16x32_bf16 v[72:75], v[44:47], v[228:231], v[72:75]
    s_waitcnt lgkmcnt(14)
    ds_read_b128 v[240:243], v6 offset:36864
    v_mfma_f32_16x16x32_bf16 v[56:59], v[48:51], v[104:107], v[56:59]
    s_waitcnt lgkmcnt(14)
    ds_read_b128 v[44:47], v3 offset:4096
    s_waitcnt lgkmcnt(14)
    ds_read_b128 v[116:119], v7 offset:4096
    s_waitcnt lgkmcnt(14)
    ds_read_b128 v[148:151], v7 offset:12288
    v_mfma_f32_16x16x32_bf16 v[60:63], v[48:51], v[136:139], v[60:63]
    s_waitcnt lgkmcnt(14)
    ds_read_b128 v[180:183], v7 offset:20480
    v_mfma_f32_16x16x32_bf16 v[64:67], v[48:51], v[168:171], v[64:67]
    s_waitcnt lgkmcnt(14)
    ds_read_b128 v[212:215], v7 offset:28672
    s_waitcnt lgkmcnt(14)
    ds_read_b128 v[244:247], v7 offset:36864
    v_mfma_f32_16x16x32_bf16 v[68:71], v[48:51], v[200:203], v[68:71]
    s_waitcnt lgkmcnt(14)
    ds_read_b128 v[120:123], v6 offset:6144
    v_mfma_f32_16x16x32_bf16 v[72:75], v[48:51], v[232:235], v[72:75]
    s_waitcnt lgkmcnt(14)
    ds_read_b128 v[152:155], v6 offset:14336
    s_waitcnt lgkmcnt(14)
    ds_read_b128 v[184:187], v6 offset:22528
    v_mfma_f32_16x16x32_bf16 v[56:59], v[52:55], v[108:111], v[56:59]
    s_waitcnt vmcnt(18)
    s_waitcnt lgkmcnt(14)
    ds_read_b128 v[48:51], v2 offset:6144
    s_add_u32 m0, s55, 2048
    s_waitcnt lgkmcnt(14)
    ds_read_b128 v[216:219], v6 offset:30720
    v_mfma_f32_16x16x32_bf16 v[60:63], v[52:55], v[140:143], v[60:63]
    buffer_load_dwordx4 v8, s[32:35], s52 offen lds
    s_waitcnt lgkmcnt(14)
    ds_read_b128 v[248:251], v6 offset:38912
    s_waitcnt lgkmcnt(14)
    ds_read_b128 v[124:127], v7 offset:6144
    v_mfma_f32_16x16x32_bf16 v[64:67], v[52:55], v[172:175], v[64:67]
    s_waitcnt lgkmcnt(14)
    ds_read_b128 v[156:159], v7 offset:14336
    v_mfma_f32_16x16x32_bf16 v[68:71], v[52:55], v[204:207], v[68:71]
    s_waitcnt lgkmcnt(14)
    ds_read_b128 v[188:191], v7 offset:22528
    s_waitcnt lgkmcnt(14)
    ds_read_b128 v[220:223], v7 offset:30720
    v_mfma_f32_16x16x32_bf16 v[72:75], v[52:55], v[236:239], v[72:75]
    s_waitcnt lgkmcnt(14)
    ds_read_b128 v[252:255], v7 offset:38912
    v_mfma_f32_16x16x32_bf16 v[56:59], v[40:43], v[112:115], v[56:59]
    s_waitcnt lgkmcnt(14)
    ds_read_b128 v[52:55], v3 offset:6144
    v_mfma_f32_16x16x32_bf16 v[60:63], v[40:43], v[144:147], v[60:63]
    buffer_load_dwordx4 v9, s[32:35], s52 offen offset:1024 lds
    s_add_u32 s52, s52, s53
    v_mfma_f32_16x16x32_bf16 v[64:67], v[40:43], v[176:179], v[64:67]
    v_and_b32 v83, 15, v1
    v_mfma_f32_16x16x32_bf16 v[68:71], v[40:43], v[208:211], v[68:71]
    v_mul_u32_u24 v83, 144, v83
    v_mfma_f32_16x16x32_bf16 v[72:75], v[40:43], v[240:243], v[72:75]
    s_lshl_b32 s26, s21, 2
    v_mfma_f32_16x16x32_bf16 v[56:59], v[44:47], v[116:119], v[56:59]
    s_waitcnt vmcnt(18)
    s_waitcnt lgkmcnt(14)
    ds_read_b128 v[40:43], v2 offset:32768
    s_add_u32 m0, s55, 4096
    s_add_u32 s26, s26, 157184
    v_mfma_f32_16x16x32_bf16 v[60:63], v[44:47], v[148:151], v[60:63]
    buffer_load_dwordx4 v8, s[32:35], s52 offen lds
    v_add_u32 v83, s26, v83
    v_mfma_f32_16x16x32_bf16 v[64:67], v[44:47], v[180:183], v[64:67]
    v_bfe_u32 v82, v1, 4, 1
    s_waitcnt lgkmcnt(14)
    v_mfma_f32_16x16x32_bf16 v[68:71], v[44:47], v[212:215], v[68:71]
    v_lshlrev_b32 v82, 5, v82
    s_waitcnt lgkmcnt(13)
    v_mfma_f32_16x16x32_bf16 v[72:75], v[44:47], v[244:247], v[72:75]
    buffer_load_dwordx4 v9, s[32:35], s52 offen offset:1024 lds
    s_add_u32 s52, s52, s53
    v_lshrrev_b32 v81, 5, v1
    s_waitcnt lgkmcnt(9)
    v_mfma_f32_16x16x32_bf16 v[56:59], v[48:51], v[120:123], v[56:59]
    ds_read_b128 v[44:47], v3 offset:32768
    v_lshlrev_b32 v81, 4, v81
    s_waitcnt lgkmcnt(2)
    v_mfma_f32_16x16x32_bf16 v[56:59], v[52:55], v[124:127], v[56:59]
    v_add3_u32 v82, v82, v81, v83
    v_mfma_f32_16x16x32_bf16 v[60:63], v[48:51], v[152:155], v[60:63]
    s_add_u32 m0, s55, 6144
    v_mfma_f32_16x16x32_bf16 v[60:63], v[52:55], v[156:159], v[60:63]
    buffer_load_dwordx4 v8, s[32:35], s52 offen lds
    v_mfma_f32_16x16x32_bf16 v[64:67], v[48:51], v[184:187], v[64:67]
    s_nop 1
    v_max3_f32 v76, v56, v57, v58
    v_max_f32 v76, v76, v59
    v_mfma_f32_16x16x32_bf16 v[64:67], v[52:55], v[188:191], v[64:67]
    v_mfma_f32_16x16x32_bf16 v[68:71], v[48:51], v[216:219], v[68:71]
    v_max3_f32 v77, v60, v61, v62
    v_max_f32 v77, v77, v63
    v_mfma_f32_16x16x32_bf16 v[68:71], v[52:55], v[220:223], v[68:71]
    buffer_load_dwordx4 v9, s[32:35], s52 offen offset:1024 lds
    s_and_b32 s52, s90, 15
    s_lshr_b64 s[90:91], s[90:91], 4
    s_mul_i32 s52, s52, s54
    s_add_u32 s52, s52, s57
    v_mfma_f32_16x16x32_bf16 v[72:75], v[48:51], v[248:251], v[72:75]
    v_max3_f32 v78, v64, v65, v66
    v_max_f32 v78, v78, v67
    v_mfma_f32_16x16x32_bf16 v[72:75], v[52:55], v[252:255], v[72:75]
    v_max3_f32 v79, v68, v69, v70
    v_max_f32 v79, v79, v71
    s_nop 5
    v_max3_f32 v80, v72, v73, v74
    v_max_f32 v80, v80, v75
    v_permlane32_swap_b32 v76, v77
    v_permlane32_swap_b32 v78, v79
    v_max_f32 v76, v76, v77
    v_max_f32 v78, v78, v79
    v_mov_b32 v81, v80
    s_nop 1
    v_permlane32_swap_b32 v80, v81
    v_max_f32 v80, v80, v81
    v_mov_b32 v81, v80
    s_nop 1
    v_permlane16_swap_b32 v80, v81
    v_max_f32 v80, v80, v81
    v_permlane16_swap_b32 v76, v78
    v_max_f32 v76, v76, v78
    ds_write_b32 v83, v80 offset:64
    ds_write_b32 v82, v76
    s_add_u32 s56, s56, 1
    s_waitcnt lgkmcnt(0)
    s_barrier
    v_and_b32 v6, 15, v1
    v_mul_u32_u24 v6, 144, v6
    v_add_u32 v6, 157184, v6
    ds_read_b128 v[76:79], v6 offset:0
    ds_read_b128 v[80:83], v6 offset:16
    ds_read_b128 v[84:87], v6 offset:32
    ds_read_b128 v[88:91], v6 offset:48
    ds_read_b128 v[92:95], v6 offset:64
    s_waitcnt lgkmcnt(4)
    v_max3_f32 v76, v76, v77, v78
    v_max_f32 v76, v76, v79
    v_sub_f32 v20, 0, v76
    v_sub_f32 v21, 0, v76
    v_sub_f32 v22, 0, v76
    v_sub_f32 v23, 0, v76
    s_waitcnt lgkmcnt(3)
    v_max3_f32 v80, v80, v81, v82
    v_max_f32 v80, v80, v83
    v_sub_f32 v24, 0, v80
    v_sub_f32 v25, 0, v80
    v_sub_f32 v26, 0, v80
    v_sub_f32 v27, 0, v80
    s_waitcnt lgkmcnt(2)
    v_max3_f32 v84, v84, v85, v86
    v_max_f32 v84, v84, v87
    v_sub_f32 v28, 0, v84
    v_sub_f32 v29, 0, v84
    v_sub_f32 v30, 0, v84
    v_sub_f32 v31, 0, v84
    s_waitcnt lgkmcnt(1)
    v_max3_f32 v88, v88, v89, v90
    v_max_f32 v88, v88, v91
    v_sub_f32 v32, 0, v88
    v_sub_f32 v33, 0, v88
    v_sub_f32 v34, 0, v88
    v_sub_f32 v35, 0, v88
    s_waitcnt lgkmcnt(0)
    v_max3_f32 v92, v92, v93, v94
    v_max_f32 v92, v92, v95
    v_sub_f32 v36, 0, v92
    v_sub_f32 v37, 0, v92
    v_sub_f32 v38, 0, v92
    v_sub_f32 v39, 0, v92
    v_add_f32 v56, v56, v20
    v_add_f32 v57, v57, v20
    v_add_f32 v58, v58, v20
    v_add_f32 v59, v59, v20
    v_add_f32 v60, v60, v24
    v_add_f32 v61, v61, v24
    v_add_f32 v62, v62, v24
    v_add_f32 v63, v63, v24
    v_add_f32 v64, v64, v28
    v_add_f32 v65, v65, v28
    v_add_f32 v66, v66, v28
    v_add_f32 v67, v67, v28
    v_add_f32 v68, v68, v32
    v_add_f32 v69, v69, v32
    v_add_f32 v70, v70, v32
    v_add_f32 v71, v71, v32
    v_add_f32 v72, v72, v36
    v_add_f32 v73, v73, v36
    v_add_f32 v74, v74, v36
    v_add_f32 v75, v75, v36
L_qloop:
    ds_read_b32 v18, v5 offset:0
    v_mfma_f32_16x16x32_bf16 v[76:79], v[40:43], v[96:99], v[20:23]
    s_waitcnt vmcnt(12)
    ds_read_b128 v[48:51], v2 offset:34816
    v_mfma_f32_16x16x32_bf16 v[80:83], v[40:43], v[128:131], v[24:27]
    ds_read_b128 v[52:55], v3 offset:34816
    v_mfma_f32_16x16x32_bf16 v[84:87], v[40:43], v[160:163], v[28:31]
    s_add_u32 m0, s55, 32768
    v_mfma_f32_16x16x32_bf16 v[88:91], v[40:43], v[192:195], v[32:35]
    buffer_load_dwordx4 v8, s[32:35], s52 offen lds
    v_mfma_f32_16x16x32_bf16 v[92:95], v[40:43], v[224:227], v[36:39]
    v_mfma_f32_16x16x32_bf16 v[76:79], v[44:47], v[100:103], v[76:79]
    s_waitcnt vmcnt(11)
    ds_read_b128 v[40:43], v2 offset:36864
    s_waitcnt lgkmcnt(3)
    v_cmp_eq_u32 vcc, s56, v18
    s_nop 0
    s_cbranch_vccnz L_qrare_odd
L_qjoin_odd:
    v_mfma_f32_16x16x32_bf16 v[80:83], v[44:47], v[132:135], v[80:83]
    v_exp_f32 v56, v56
    v_exp_f32 v57, v57
    v_exp_f32 v58, v58
    v_mfma_f32_16x16x32_bf16 v[84:87], v[44:47], v[164:167], v[84:87]
    v_exp_f32 v59, v59
    v_add_f32 v6, v56, v57
    v_mfma_f32_16x16x32_bf16 v[88:91], v[44:47], v[196:199], v[88:91]
    buffer_load_dwordx4 v9, s[32:35], s52 offen offset:1024 lds
    s_add_u32 s52, s52, s53
    v_add_f32 v7, v58, v59
    v_cvt_pk_bf16_f32 v56, v56, v57
    v_mfma_f32_16x16x32_bf16 v[92:95], v[44:47], v[228:231], v[92:95]
    v_cvt_pk_bf16_f32 v57, v58, v59
    v_add_f32 v6, v6, v7
    s_waitcnt lgkmcnt(2)
    v_mfma_f32_16x16x32_bf16 v[76:79], v[48:51], v[104:107], v[76:79]
    ds_read_b128 v[44:47], v3 offset:36864
    v_add_f32 v11, v11, v6
    v_exp_f32 v60, v60
    v_mfma_f32_16x16x32_bf16 v[80:83], v[48:51], v[136:139], v[80:83]
    v_exp_f32 v61, v61
    v_exp_f32 v62, v62
    v_exp_f32 v63, v63
    v_mfma_f32_16x16x32_bf16 v[84:87], v[48:51], v[168:171], v[84:87]
    v_add_f32 v16, v60, v61
    v_add_f32 v17, v62, v63
    v_mfma_f32_16x16x32_bf16 v[88:91], v[48:51], v[200:203], v[88:91]
    v_cvt_pk_bf16_f32 v58, v60, v61
    v_cvt_pk_bf16_f32 v59, v62, v63
    v_mfma_f32_16x16x32_bf16 v[92:95], v[48:51], v[232:235], v[92:95]
    v_add_f32 v16, v16, v17
    v_permlane16_swap_b32 v56, v58
    s_waitcnt lgkmcnt(2)
    v_mfma_f32_16x16x32_bf16 v[76:79], v[52:55], v[108:111], v[76:79]
    s_waitcnt vmcnt(10)
    ds_read_b128 v[48:51], v2 offset:38912
    s_add_u32 m0, s55, 34816
    v_permlane16_swap_b32 v57, v59
    ds_write_b128 v10, v[56:59] offset:0
    v_mfma_f32_16x16x32_bf16 v[80:83], v[52:55], v[140:143], v[80:83]
    buffer_load_dwordx4 v8, s[32:35], s52 offen lds
    v_add_f32 v12, v12, v16
    v_exp_f32 v64, v64
    v_exp_f32 v65, v65
    v_mfma_f32_16x16x32_bf16 v[84:87], v[52:55], v[172:175], v[84:87]
    v_exp_f32 v66, v66
    v_exp_f32 v67, v67
    v_mfma_f32_16x16x32_bf16 v[88:91], v[52:55], v[204:207], v[88:91]
    v_add_f32 v6, v64, v65
    v_add_f32 v7, v66, v67
    v_mfma_f32_16x16x32_bf16 v[92:95], v[52:55], v[236:239], v[92:95]
    v_cvt_pk_bf16_f32 v64, v64, v65
    v_cvt_pk_bf16_f32 v65, v66, v67
    s_waitcnt lgkmcnt(3)
    v_mfma_f32_16x16x32_bf16 v[76:79], v[40:43], v[112:115], v[76:79]
    ds_read_b128 v[52:55], v3 offset:38912
    v_add_f32 v6, v6, v7
    v_add_f32 v13, v13, v6
    v_mfma_f32_16x16x32_bf16 v[80:83], v[40:43], v[144:147], v[80:83]
    buffer_load_dwordx4 v9, s[32:35], s52 offen offset:1024 lds
    s_add_u32 s52, s52, s53
    v_exp_f32 v68, v68
    v_exp_f32 v69, v69
    v_exp_f32 v70, v70
    v_mfma_f32_16x16x32_bf16 v[84:87], v[40:43], v[176:179], v[84:87]
    v_exp_f32 v71, v71
    v_add_f32 v16, v68, v69
    v_mfma_f32_16x16x32_bf16 v[88:91], v[40:43], v[208:211], v[88:91]
    v_add_f32 v17, v70, v71
    v_cvt_pk_bf16_f32 v66, v68, v69
    v_mfma_f32_16x16x32_bf16 v[92:95], v[40:43], v[240:243], v[92:95]
    v_cvt_pk_bf16_f32 v67, v70, v71
    v_add_f32 v16, v16, v17
    s_waitcnt lgkmcnt(3)
    v_mfma_f32_16x16x32_bf16 v[76:79], v[44:47], v[116:119], v[76:79]
    s_waitcnt vmcnt(10)
    ds_read_b128 v[40:43], v2 offset:0
    s_add_u32 m0, s55, 36864
    v_permlane16_swap_b32 v64, v66
    v_permlane16_swap_b32 v65, v67
    v_mfma_f32_16x16x32_bf16 v[80:83], v[44:47], v[148:151], v[80:83]
    buffer_load_dwordx4 v8, s[32:35], s52 offen lds
    ds_write_b128 v10, v[64:67] offset:4096
    v_add_f32 v14, v14, v16
    v_exp_f32 v72, v72
    v_mfma_f32_16x16x32_bf16 v[84:87], v[44:47], v[180:183], v[84:87]
    v_exp_f32 v73, v73
    v_exp_f32 v74, v74
    v_mfma_f32_16x16x32_bf16 v[88:91], v[44:47], v[212:215], v[88:91]
    v_exp_f32 v75, v75
    v_add_f32 v6, v72, v73
    v_mfma_f32_16x16x32_bf16 v[92:95], v[44:47], v[244:247], v[92:95]
    buffer_load_dwordx4 v9, s[32:35], s52 offen offset:1024 lds
    s_add_u32 s52, s52, s53
    v_add_f32 v7, v74, v75
    v_cvt_pk_bf16_f32 v72, v72, v73
    s_waitcnt lgkmcnt(4)
    v_mfma_f32_16x16x32_bf16 v[76:79], v[48:51], v[120:123], v[76:79]
    ds_read_b128 v[44:47], v3 offset:0
    v_cvt_pk_bf16_f32 v73, v74, v75
    v_add_f32 v6, v6, v7
    s_waitcnt lgkmcnt(3)
    v_mfma_f32_16x16x32_bf16 v[76:79], v[52:55], v[124:127], v[76:79]
    ds_write_b64 v4, v[72:73] offset:8192
    v_add_f32 v15, v15, v6
    v_mfma_f32_16x16x32_bf16 v[80:83], v[48:51], v[152:155], v[80:83]
    s_add_u32 m0, s55, 38912
    v_mfma_f32_16x16x32_bf16 v[80:83], v[52:55], v[156:159], v[80:83]
    buffer_load_dwordx4 v8, s[32:35], s52 offen lds
    v_mfma_f32_16x16x32_bf16 v[84:87], v[48:51], v[184:187], v[84:87]
    s_nop 0
    v_max3_f32 v18, v76, v77, v78
    v_mov_b32 v19, v79
    v_mfma_f32_16x16x32_bf16 v[84:87], v[52:55], v[188:191], v[84:87]
    v_mfma_f32_16x16x32_bf16 v[88:91], v[48:51], v[216:219], v[88:91]
    s_nop 0
    v_max3_f32 v18, v18, v80, v81
    v_max3_f32 v19, v19, v82, v83
    v_mfma_f32_16x16x32_bf16 v[88:91], v[52:55], v[220:223], v[88:91]
    buffer_load_dwordx4 v9, s[32:35], s52 offen offset:1024 lds
    s_and_b32 s52, s90, 15
    s_lshr_b64 s[90:91], s[90:91], 4
    s_mul_i32 s52, s52, s54
    s_add_u32 s52, s52, s57
    v_mfma_f32_16x16x32_bf16 v[92:95], v[48:51], v[248:251], v[92:95]
    v_max3_f32 v18, v18, v84, v85
    v_max3_f32 v19, v19, v86, v87
    v_mfma_f32_16x16x32_bf16 v[92:95], v[52:55], v[252:255], v[92:95]
    v_max3_f32 v18, v18, v88, v89
    v_max3_f32 v19, v19, v90, v91
    s_nop 5
    v_max3_f32 v18, v18, v92, v93
    v_max3_f32 v19, v19, v94, v95
    v_max_f32 v18, v18, v19
    v_cmp_lt_f32 vcc, 0x41000000, v18
    s_nop 0
    s_cbranch_vccnz L_qsetf_odd
L_qsetj_odd:
    s_add_u32 s56, s56, 1
    s_waitcnt lgkmcnt(0)
    s_barrier
    s_cmp_eq_u32 s56, 16
    s_cbranch_scc1 L_qdone
    s_cmp_eq_u32 s56, 14
    s_cbranch_scc0 L_qnosw
    s_mov_b32 s32, s44
    s_mov_b32 s33, s45
    s_mov_b32 s34, s46
    s_lshl_b32 s52, s58, 7
    s_mov_b32 s57, s52
    s_mov_b32 s53, 14336
    s_mov_b32 s54, 57344
    s_mov_b32 s90, 0x4321
    v_lshrrev_b32 v6, 3, v1
    v_and_b32 v6, 2, v6
    v_and_b32 v7, 7, v1
    v_xor_b32 v6, v6, v7
    v_lshlrev_b32 v6, 4, v6
    v_lshrrev_b32 v7, 3, v1
    v_mul_u32_u24 v7, 896, v7
    v_add_u32 v8, v6, v7
    v_xor_b32 v6, 64, v6
    v_add_u32 v9, v6, v7
    v_add_u32 v9, 6144, v9
L_qnosw:
    ds_read_b32 v18, v5 offset:4
    v_mfma_f32_16x16x32_bf16 v[56:59], v[40:43], v[96:99], v[20:23]
    s_waitcnt vmcnt(12)
    ds_read_b128 v[48:51], v2 offset:2048
    v_mfma_f32_16x16x32_bf16 v[60:63], v[40:43], v[128:131], v[24:27]
    ds_read_b128 v[52:55], v3 offset:2048
    v_mfma_f32_16x16x32_bf16 v[64:67], v[40:43], v[160:163], v[28:31]
    s_add_u32 m0, s55, 0
    v_mfma_f32_16x16x32_bf16 v[68:71], v[40:43], v[192:195], v[32:35]
    buffer_load_dwordx4 v8, s[32:35], s52 offen lds
    v_mfma_f32_16x16x32_bf16 v[72:75], v[40:43], v[224:227], v[36:39]
    v_mfma_f32_16x16x32_bf16 v[56:59], v[44:47], v[100:103], v[56:59]
    s_waitcnt vmcnt(11)
    ds_read_b128 v[40:43], v2 offset:4096
    s_waitcnt lgkmcnt(3)
    v_cmp_eq_u32 vcc, s56, v18
    s_nop 0
    s_cbranch_vccnz L_qrare_even
L_qjoin_even:
    v_mfma_f32_16x16x32_bf16 v[60:63], v[44:47], v[132:135], v[60:63]
    v_exp_f32 v76, v76
    v_exp_f32 v77, v77
    v_exp_f32 v78, v78
    v_mfma_f32_16x16x32_bf16 v[64:67], v[44:47], v[164:167], v[64:67]
    v_exp_f32 v79, v79
    v_add_f32 v6, v76, v77
    v_mfma_f32_16x16x32_bf16 v[68:71], v[44:47], v[196:199], v[68:71]
    buffer_load_dwordx4 v9, s[32:35], s52 offen offset:1024 lds
    s_add_u32 s52, s52, s53
    v_add_f32 v7, v78, v79
    v_cvt_pk_bf16_f32 v76, v76, v77
    v_mfma_f32_16x16x32_bf16 v[72:75], v[44:47], v[228:231], v[72:75]
    v_cvt_pk_bf16_f32 v77, v78, v79
    v_add_f32 v6, v6, v7
    s_waitcnt lgkmcnt(2)
    v_mfma_f32_16x16x32_bf16 v[56:59], v[48:51], v[104:107], v[56:59]
    ds_read_b128 v[44:47], v3 offset:4096
    v_add_f32 v11, v11, v6
    v_exp_f32 v80, v80
    v_mfma_f32_16x16x32_bf16 v[60:63], v[48:51], v[136:139], v[60:63]
    v_exp_f32 v81, v81
    v_exp_f32 v82, v82
    v_exp_f32 v83, v83
    v_mfma_f32_16x16x32_bf16 v[64:67], v[48:51], v[168:171], v[64:67]
    v_add_f32 v16, v80, v81
    v_add_f32 v17, v82, v83
    v_mfma_f32_16x16x32_bf16 v[68:71], v[48:51], v[200:203], v[68:71]
    v_cvt_pk_bf16_f32 v78, v80, v81
    v_cvt_pk_bf16_f32 v79, v82, v83
    v_mfma_f32_16x16x32_bf16 v[72:75], v[48:51], v[232:235], v[72:75]
    v_add_f32 v16, v16, v17
    v_permlane16_swap_b32 v76, v78
    s_waitcnt lgkmcnt(2)
    v_mfma_f32_16x16x32_bf16 v[56:59], v[52:55], v[108:111], v[56:59]
    s_waitcnt vmcnt(10)
    ds_read_b128 v[48:51], v2 offset:6144
    s_add_u32 m0, s55, 2048
    v_permlane16_swap_b32 v77, v79
    ds_write_b128 v10, v[76:79] offset:10240
    v_mfma_f32_16x16x32_bf16 v[60:63], v[52:55], v[140:143], v[60:63]
    buffer_load_dwordx4 v8, s[32:35], s52 offen lds
    v_add_f32 v12, v12, v16
    v_exp_f32 v84, v84
    v_exp_f32 v85, v85
    v_mfma_f32_16x16x32_bf16 v[64:67], v[52:55], v[172:175], v[64:67]
    v_exp_f32 v86, v86
    v_exp_f32 v87, v87
    v_mfma_f32_16x16x32_bf16 v[68:71], v[52:55], v[204:207], v[68:71]
    v_add_f32 v6, v84, v85
    v_add_f32 v7, v86, v87
    v_mfma_f32_16x16x32_bf16 v[72:75], v[52:55], v[236:239], v[72:75]
    v_cvt_pk_bf16_f32 v84, v84, v85
    v_cvt_pk_bf16_f32 v85, v86, v87
    s_waitcnt lgkmcnt(3)
    v_mfma_f32_16x16x32_bf16 v[56:59], v[40:43], v[112:115], v[56:59]
    ds_read_b128 v[52:55], v3 offset:6144
    v_add_f32 v6, v6, v7
    v_add_f32 v13, v13, v6
    v_mfma_f32_16x16x32_bf16 v[60:63], v[40:43], v[144:147], v[60:63]
    buffer_load_dwordx4 v9, s[32:35], s52 offen offset:1024 lds
    s_add_u32 s52, s52, s53
    v_exp_f32 v88, v88
    v_exp_f32 v89, v89
    v_exp_f32 v90, v90
    v_mfma_f32_16x16x32_bf16 v[64:67], v[40:43], v[176:179], v[64:67]
    v_exp_f32 v91, v91
    v_add_f32 v16, v88, v89
    v_mfma_f32_16x16x32_bf16 v[68:71], v[40:43], v[208:211], v[68:71]
    v_add_f32 v17, v90, v91
    v_cvt_pk_bf16_f32 v86, v88, v89
    v_mfma_f32_16x16x32_bf16 v[72:75], v[40:43], v[240:243], v[72:75]
    v_cvt_pk_bf16_f32 v87, v90, v91
    v_add_f32 v16, v16, v17
    s_waitcnt lgkmcnt(3)
    v_mfma_f32_16x16x32_bf16 v[56:59], v[44:47], v[116:119], v[56:59]
    s_waitcnt vmcnt(10)
    ds_read_b128 v[40:43], v2 offset:32768
    s_add_u32 m0, s55, 4096
    v_permlane16_swap_b32 v84, v86
    v_permlane16_swap_b32 v85, v87
    v_mfma_f32_16x16x32_bf16 v[60:63], v[44:47], v[148:151], v[60:63]
    buffer_load_dwordx4 v8, s[32:35], s52 offen lds
    ds_write_b128 v10, v[84:87] offset:14336
    v_add_f32 v14, v14, v16
    v_exp_f32 v92, v92
    v_mfma_f32_16x16x32_bf16 v[64:67], v[44:47], v[180:183], v[64:67]
    v_exp_f32 v93, v93
    v_exp_f32 v94, v94
    v_mfma_f32_16x16x32_bf16 v[68:71], v[44:47], v[212:215], v[68:71]
    v_exp_f32 v95, v95
    v_add_f32 v6, v92, v93
    v_mfma_f32_16x16x32_bf16 v[72:75], v[44:47], v[244:247], v[72:75]
    buffer_load_dwordx4 v9, s[32:35], s52 offen offset:1024 lds
    s_add_u32 s52, s52, s53
    v_add_f32 v7, v94, v95
    v_cvt_pk_bf16_f32 v92, v92, v93
    s_waitcnt lgkmcnt(4)
    v_mfma_f32_16x16x32_bf16 v[56:59], v[48:51], v[120:123], v[56:59]
    ds_read_b128 v[44:47], v3 offset:32768
    v_cvt_pk_bf16_f32 v93, v94, v95
    v_add_f32 v6, v6, v7
    s_waitcnt lgkmcnt(3)
    v_mfma_f32_16x16x32_bf16 v[56:59], v[52:55], v[124:127], v[56:59]
    ds_write_b64 v4, v[92:93] offset:18432
    v_add_f32 v15, v15, v6
    v_mfma_f32_16x16x32_bf16 v[60:63], v[48:51], v[152:155], v[60:63]
    s_add_u32 m0, s55, 6144
    v_mfma_f32_16x16x32_bf16 v[60:63], v[52:55], v[156:159], v[60:63]
    buffer_load_dwordx4 v8, s[32:35], s52 offen lds
    v_mfma_f32_16x16x32_bf16 v[64:67], v[48:51], v[184:187], v[64:67]
    s_nop 0
    v_max3_f32 v18, v56, v57, v58
    v_mov_b32 v19, v59
    v_mfma_f32_16x16x32_bf16 v[64:67], v[52:55], v[188:191], v[64:67]
    v_mfma_f32_16x16x32_bf16 v[68:71], v[48:51], v[216:219], v[68:71]
    s_nop 0
    v_max3_f32 v18, v18, v60, v61
    v_max3_f32 v19, v19, v62, v63
    v_mfma_f32_16x16x32_bf16 v[68:71], v[52:55], v[220:223], v[68:71]
    buffer_load_dwordx4 v9, s[32:35], s52 offen offset:1024 lds
    s_and_b32 s52, s90, 15
    s_lshr_b64 s[90:91], s[90:91], 4
    s_mul_i32 s52, s52, s54
    s_add_u32 s52, s52, s57
    v_mfma_f32_16x16x32_bf16 v[72:75], v[48:51], v[248:251], v[72:75]
    v_max3_f32 v18, v18, v64, v65
    v_max3_f32 v19, v19, v66, v67
    v_mfma_f32_16x16x32_bf16 v[72:75], v[52:55], v[252:255], v[72:75]
    v_max3_f32 v18, v18, v68, v69
    v_max3_f32 v19, v19, v70, v71
    s_nop 5
    v_max3_f32 v18, v18, v72, v73
    v_max3_f32 v19, v19, v74, v75
    v_max_f32 v18, v18, v19
    v_cmp_lt_f32 vcc, 0x41000000, v18
    s_nop 0
    s_cbranch_vccnz L_qsetf_even
L_qsetj_even:
    s_add_u32 s56, s56, 1
    s_waitcnt lgkmcnt(0)
    s_barrier
    s_branch L_qloop
L_qdone:
    ds_read_b32 v18, v5 offset:4
    s_waitcnt lgkmcnt(0)
    v_cmp_eq_u32 vcc, s56, v18
    s_nop 0
    s_cbranch_vccnz L_qrare_p16
L_qjoin_p16:
    v_exp_f32 v76, v76
    v_exp_f32 v77, v77
    v_exp_f32 v78, v78
    v_exp_f32 v79, v79
    v_add_f32 v6, v76, v77
    v_add_f32 v7, v78, v79
    v_cvt_pk_bf16_f32 v76, v76, v77
    v_cvt_pk_bf16_f32 v77, v78, v79
    v_add_f32 v6, v6, v7
    v_add_f32 v11, v11, v6
    v_exp_f32 v80, v80
    v_exp_f32 v81, v81
    v_exp_f32 v82, v82
    v_exp_f32 v83, v83
    v_add_f32 v16, v80, v81
    v_add_f32 v17, v82, v83
    v_cvt_pk_bf16_f32 v78, v80, v81
    v_cvt_pk_bf16_f32 v79, v82, v83
    v_add_f32 v16, v16, v17
    v_permlane16_swap_b32 v76, v78
    v_permlane16_swap_b32 v77, v79
    ds_write_b128 v10, v[76:79] offset:10240
    v_add_f32 v12, v12, v16
    v_exp_f32 v84, v84
    v_exp_f32 v85, v85
    v_exp_f32 v86, v86
    v_exp_f32 v87, v87
    v_add_f32 v6, v84, v85
    v_add_f32 v7, v86, v87
    v_cvt_pk_bf16_f32 v84, v84, v85
    v_cvt_pk_bf16_f32 v85, v86, v87
    v_add_f32 v6, v6, v7
    v_add_f32 v13, v13, v6
    v_exp_f32 v88, v88
    v_exp_f32 v89, v89
    v_exp_f32 v90, v90
    v_exp_f32 v91, v91
    v_add_f32 v16, v88, v89
    v_add_f32 v17, v90, v91
    v_cvt_pk_bf16_f32 v86, v88, v89
    v_cvt_pk_bf16_f32 v87, v90, v91
    v_add_f32 v16, v16, v17
    v_permlane16_swap_b32 v84, v86
    v_permlane16_swap_b32 v85, v87
    ds_write_b128 v10, v[84:87] offset:14336
    v_add_f32 v14, v14, v16
    v_exp_f32 v92, v92
    v_exp_f32 v93, v93
    v_exp_f32 v94, v94
    v_exp_f32 v95, v95
    v_add_f32 v6, v92, v93
    v_add_f32 v7, v94, v95
    v_cvt_pk_bf16_f32 v92, v92, v93
    v_cvt_pk_bf16_f32 v93, v94, v95
    v_add_f32 v6, v6, v7
    ds_write_b64 v4, v[92:93] offset:18432
    v_add_f32 v15, v15, v6
    v_and_b32 v40, 15, v1
    v_mul_u32_u24 v40, 144, v40
    s_lshl_b32 s26, s21, 2
    s_add_u32 s26, s26, 160256
    v_add_u32 v40, s26, v40
    v_bfe_u32 v41, v1, 4, 1
    v_lshlrev_b32 v41, 5, v41
    v_lshrrev_b32 v42, 5, v1
    v_lshlrev_b32 v42, 4, v42
    v_add3_u32 v41, v41, v42, v40
    v_permlane32_swap_b32 v11, v12
    v_permlane32_swap_b32 v13, v14
    v_add_f32 v11, v11, v12
    v_add_f32 v13, v13, v14
    v_mov_b32 v42, v15
    s_nop 1
    v_permlane32_swap_b32 v15, v42
    v_add_f32 v15, v15, v42
    v_mov_b32 v42, v15
    s_nop 1
    v_permlane16_swap_b32 v15, v42
    v_add_f32 v15, v15, v42
    v_permlane16_swap_b32 v11, v13
    v_add_f32 v11, v11, v13
    ds_write_b32 v40, v15 offset:64
    ds_write_b32 v41, v11
    v_mov_b32 v42, 159744
    v_mov_b32 v44, 0
    v_mov_b32 v45, 0
    v_mov_b32 v46, 0
    v_mov_b32 v47, 0
    s_mov_b64 exec, 1
    ds_write_b128 v42, v[44:47]
    s_mov_b64 exec, -1
    v_lshrrev_b32 v17, 4, v1
    v_lshlrev_b32 v17, 10, v17
    v_bfe_u32 v18, v1, 2, 2
    v_lshlrev_b32 v18, 7, v18
    v_add_u32 v17, v17, v18
    v_and_b32 v18, 3, v1
    v_lshlrev_b32 v18, 3, v18
    v_add_u32 v17, v17, v18
    v_bfe_u32 v18, v1, 3, 2
    v_lshlrev_b32 v18, 5, v18
    v_add_u32 v19, v17, v18
    s_waitcnt lgkmcnt(0)
    v_add_u32 v2, s55, v19
    v_xor_b32 v3, 32, v2
    v_xor_b32 v4, 64, v2
    v_xor_b32 v5, 96, v2
    s_waitcnt vmcnt(8)
    ds_read_b64_tr_b16 v[128:129], v2 offset:0
    ds_read_b64_tr_b16 v[130:131], v2 offset:512
    ds_read_b64_tr_b16 v[132:133], v3 offset:0
    ds_read_b64_tr_b16 v[134:135], v3 offset:512
    ds_read_b64_tr_b16 v[136:137], v4 offset:0
    ds_read_b64_tr_b16 v[138:139], v4 offset:512
    ds_read_b64_tr_b16 v[140:141], v5 offset:0
    ds_read_b64_tr_b16 v[142:143], v5 offset:512
    ds_read_b64_tr_b16 v[144:145], v2 offset:4096
    ds_read_b64_tr_b16 v[146:147], v2 offset:4608
    ds_read_b64_tr_b16 v[148:149], v3 offset:4096
    ds_read_b64_tr_b16 v[150:151], v3 offset:4608
    ds_read_b64_tr_b16 v[152:153], v4 offset:4096
    ds_read_b64_tr_b16 v[154:155], v4 offset:4608
    ds_read_b64_tr_b16 v[156:157], v5 offset:4096
    s_waitcnt lgkmcnt(14)
    ds_read_b64_tr_b16 v[158:159], v5 offset:4608
    s_add_u32 s56, s56, 1
    s_waitcnt lgkmcnt(0)
    s_barrier
    s_waitcnt vmcnt(0)
    ds_read_b64_tr_b16 v[160:161], v2 offset:32768
    ds_read_b64_tr_b16 v[162:163], v2 offset:33280
    ds_read_b64_tr_b16 v[164:165], v3 offset:32768
    ds_read_b64_tr_b16 v[166:167], v3 offset:33280
    ds_read_b64_tr_b16 v[168:169], v4 offset:32768
    ds_read_b64_tr_b16 v[170:171], v4 offset:33280
    ds_read_b64_tr_b16 v[172:173], v5 offset:32768
    ds_read_b64_tr_b16 v[174:175], v5 offset:33280
    ds_read_b64_tr_b16 v[176:177], v2 offset:36864
    ds_read_b64_tr_b16 v[178:179], v2 offset:37376
    ds_read_b64_tr_b16 v[180:181], v3 offset:36864
    ds_read_b64_tr_b16 v[182:183], v3 offset:37376
    ds_read_b64_tr_b16 v[184:185], v4 offset:36864
    ds_read_b64_tr_b16 v[186:187], v4 offset:37376
    ds_read_b64_tr_b16 v[188:189], v5 offset:36864
    s_waitcnt lgkmcnt(14)
    ds_read_b64_tr_b16 v[190:191], v5 offset:37376
    s_add_u32 m0, s55, 0
    s_nop 0
    buffer_load_dwordx4 v8, s[32:35], s52 offen lds
    buffer_load_dwordx4 v9, s[32:35], s52 offen offset:1024 lds
    s_add_u32 s52, s52, s53
    s_add_u32 m0, s55, 2048
    s_nop 0
    buffer_load_dwordx4 v8, s[32:35], s52 offen lds
    buffer_load_dwordx4 v9, s[32:35], s52 offen offset:1024 lds
    s_add_u32 s52, s52, s53
    s_add_u32 m0, s55, 4096
    s_nop 0
    buffer_load_dwordx4 v8, s[32:35], s52 offen lds
    buffer_load_dwordx4 v9, s[32:35], s52 offen offset:1024 lds
    s_add_u32 s52, s52, s53
    s_add_u32 m0, s55, 6144
    s_nop 0
    buffer_load_dwordx4 v8, s[32:35], s52 offen lds
    buffer_load_dwordx4 v9, s[32:35], s52 offen offset:1024 lds
    s_and_b32 s52, s90, 15
    s_lshr_b64 s[90:91], s[90:91], 4
    s_mul_i32 s52, s52, s54
    s_add_u32 s52, s52, s57
    s_barrier
    v_and_b32 v17, 15, v1
    v_and_b32 v18, 7, v1
    v_lshlrev_b32 v17, 7, v17
    v_lshrrev_b32 v6, 4, v1
    v_xor_b32 v18, v18, v6
    v_lshlrev_b32 v18, 4, v18
    v_add_u32 v6, v17, v18
    v_xor_b32 v7, 64, v6
    v_add_u32 v6, 90112, v6
    v_add_u32 v7, 90112, v7
    v_and_b32 v18, 15, v1
    v_mul_u32_u24 v18, 144, v18
    v_add_u32 v18, 160256, v18
    s_waitcnt lgkmcnt(14)
    ds_read_b128 v[24:27], v18 offset:0
    s_waitcnt lgkmcnt(14)
    ds_read_b128 v[28:31], v18 offset:16
    s_waitcnt lgkmcnt(14)
    ds_read_b128 v[32:35], v18 offset:32
    s_waitcnt lgkmcnt(14)
    ds_read_b128 v[36:39], v18 offset:48
    s_waitcnt lgkmcnt(14)
    ds_read_b128 v[40:43], v18 offset:64
    s_waitcnt lgkmcnt(4)
    v_add_f32 v24, v24, v25
    v_add_f32 v26, v26, v27
    v_add_f32 v24, v24, v26
    v_rcp_f32 v10, v24
    s_waitcnt lgkmcnt(3)
    v_add_f32 v28, v28, v29
    v_add_f32 v30, v30, v31
    v_add_f32 v28, v28, v30
    v_rcp_f32 v11, v28
    s_waitcnt lgkmcnt(2)
    v_add_f32 v32, v32, v33
    v_add_f32 v34, v34, v35
    v_add_f32 v32, v32, v34
    v_rcp_f32 v12, v32
    s_waitcnt lgkmcnt(1)
    v_add_f32 v36, v36, v37
    v_add_f32 v38, v38, v39
    v_add_f32 v36, v36, v38
    v_rcp_f32 v13, v36
    s_waitcnt lgkmcnt(0)
    v_add_f32 v40, v40, v41
    v_add_f32 v42, v42, v43
    v_add_f32 v40, v40, v42
    v_rcp_f32 v14, v40
    s_waitcnt lgkmcnt(0)
    s_barrier
    s_branch L_oproj_q
L_qsetf_odd:
    s_add_u32 s26, s56, 1
    v_mov_b32 v18, s26
    ds_write_b32 v5, v18 offset:4
    s_branch L_qsetj_odd
L_qsetf_even:
    s_add_u32 s26, s56, 1
    v_mov_b32 v18, s26
    ds_write_b32 v5, v18 offset:0
    s_branch L_qsetj_even
L_qrare_odd:
    s_nop 9
    v_and_b32 v7, 15, v1
    v_lshlrev_b32 v7, 5, v7
    v_add_u32 v7, 155648, v7
    s_lshl_b32 s26, s21, 9
    v_add_u32 v16, s26, v7
    v_max3_f32 v19, v56, v57, v58
    v_max_f32 v19, v19, v59
    v_mov_b32 v6, v19
    s_nop 1
    v_permlane32_swap_b32 v19, v6
    v_max_f32 v19, v19, v6
    v_mov_b32 v6, v19
    s_nop 1
    v_permlane16_swap_b32 v19, v6
    v_max_f32 v19, v19, v6
    ds_write_b32 v16, v19 offset:1536
    v_max3_f32 v19, v60, v61, v62
    v_max_f32 v19, v19, v63
    v_mov_b32 v6, v19
    s_nop 1
    v_permlane32_swap_b32 v19, v6
    v_max_f32 v19, v19, v6
    v_mov_b32 v6, v19
    s_nop 1
    v_permlane16_swap_b32 v19, v6
    v_max_f32 v19, v19, v6
    ds_write_b32 v16, v19 offset:1540
    v_max3_f32 v19, v64, v65, v66
    v_max_f32 v19, v19, v67
    v_mov_b32 v6, v19
    s_nop 1
    v_permlane32_swap_b32 v19, v6
    v_max_f32 v19, v19, v6
    v_mov_b32 v6, v19
    s_nop 1
    v_permlane16_swap_b32 v19, v6
    v_max_f32 v19, v19, v6
    ds_write_b32 v16, v19 offset:1544
    v_max3_f32 v19, v68, v69, v70
    v_max_f32 v19, v19, v71
    v_mov_b32 v6, v19
    s_nop 1
    v_permlane32_swap_b32 v19, v6
    v_max_f32 v19, v19, v6
    v_mov_b32 v6, v19
    s_nop 1
    v_permlane16_swap_b32 v19, v6
    v_max_f32 v19, v19, v6
    ds_write_b32 v16, v19 offset:1548
    v_max3_f32 v19, v72, v73, v74
    v_max_f32 v19, v19, v75
    v_mov_b32 v6, v19
    s_nop 1
    v_permlane32_swap_b32 v19, v6
    v_max_f32 v19, v19, v6
    v_mov_b32 v6, v19
    s_nop 1
    v_permlane16_swap_b32 v19, v6
    v_max_f32 v19, v19, v6
    ds_write_b32 v16, v19 offset:1552
    s_waitcnt lgkmcnt(0)
    s_barrier
    ds_read_b32 v16, v7 offset:1536
    ds_read_b32 v17, v7 offset:2048
    ds_read_b32 v18, v7 offset:2560
    ds_read_b32 v6, v7 offset:3072
    s_waitcnt lgkmcnt(1)
    v_max3_f32 v19, v16, v17, v18
    s_waitcnt lgkmcnt(0)
    v_max3_f32 v19, v19, v6, 0
    v_sub_f32 v56, v56, v19
    v_sub_f32 v76, v76, v19
    v_sub_f32 v20, v20, v19
    v_sub_f32 v57, v57, v19
    v_sub_f32 v77, v77, v19
    v_sub_f32 v21, v21, v19
    v_sub_f32 v58, v58, v19
    v_sub_f32 v78, v78, v19
    v_sub_f32 v22, v22, v19
    v_sub_f32 v59, v59, v19
    v_sub_f32 v79, v79, v19
    v_sub_f32 v23, v23, v19
    v_exp_f32 v6, -v19
    s_nop 0
    v_mul_f32 v11, v11, v6
    ds_write_b32 v7, v6 offset:512
    ds_read_b32 v16, v7 offset:1540
    ds_read_b32 v17, v7 offset:2052
    ds_read_b32 v18, v7 offset:2564
    ds_read_b32 v6, v7 offset:3076
    s_waitcnt lgkmcnt(1)
    v_max3_f32 v19, v16, v17, v18
    s_waitcnt lgkmcnt(0)
    v_max3_f32 v19, v19, v6, 0
    v_sub_f32 v60, v60, v19
    v_sub_f32 v80, v80, v19
    v_sub_f32 v24, v24, v19
    v_sub_f32 v61, v61, v19
    v_sub_f32 v81, v81, v19
    v_sub_f32 v25, v25, v19
    v_sub_f32 v62, v62, v19
    v_sub_f32 v82, v82, v19
    v_sub_f32 v26, v26, v19
    v_sub_f32 v63, v63, v19
    v_sub_f32 v83, v83, v19
    v_sub_f32 v27, v27, v19
    v_exp_f32 v6, -v19
    s_nop 0
    v_mul_f32 v12, v12, v6
    ds_write_b32 v7, v6 offset:516
    ds_read_b32 v16, v7 offset:1544
    ds_read_b32 v17, v7 offset:2056
    ds_read_b32 v18, v7 offset:2568
    ds_read_b32 v6, v7 offset:3080
    s_waitcnt lgkmcnt(1)
    v_max3_f32 v19, v16, v17, v18
    s_waitcnt lgkmcnt(0)
    v_max3_f32 v19, v19, v6, 0
    v_sub_f32 v64, v64, v19
    v_sub_f32 v84, v84, v19
    v_sub_f32 v28, v28, v19
    v_sub_f32 v65, v65, v19
    v_sub_f32 v85, v85, v19
    v_sub_f32 v29, v29, v19
    v_sub_f32 v66, v66, v19
    v_sub_f32 v86, v86, v19
    v_sub_f32 v30, v30, v19
    v_sub_f32 v67, v67, v19
    v_sub_f32 v87, v87, v19
    v_sub_f32 v31, v31, v19
    v_exp_f32 v6, -v19
    s_nop 0
    v_mul_f32 v13, v13, v6
    ds_write_b32 v7, v6 offset:520
    ds_read_b32 v16, v7 offset:1548
    ds_read_b32 v17, v7 offset:2060
    ds_read_b32 v18, v7 offset:2572
    ds_read_b32 v6, v7 offset:3084
    s_waitcnt lgkmcnt(1)
    v_max3_f32 v19, v16, v17, v18
    s_waitcnt lgkmcnt(0)
    v_max3_f32 v19, v19, v6, 0
    v_sub_f32 v68, v68, v19
    v_sub_f32 v88, v88, v19
    v_sub_f32 v32, v32, v19
    v_sub_f32 v69, v69, v19
    v_sub_f32 v89, v89, v19
    v_sub_f32 v33, v33, v19
    v_sub_f32 v70, v70, v19
    v_sub_f32 v90, v90, v19
    v_sub_f32 v34, v34, v19
    v_sub_f32 v71, v71, v19
    v_sub_f32 v91, v91, v19
    v_sub_f32 v35, v35, v19
    v_exp_f32 v6, -v19
    s_nop 0
    v_mul_f32 v14, v14, v6
    ds_write_b32 v7, v6 offset:524
    ds_read_b32 v16, v7 offset:1552
    ds_read_b32 v17, v7 offset:2064
    ds_read_b32 v18, v7 offset:2576
    ds_read_b32 v6, v7 offset:3088
    s_waitcnt lgkmcnt(1)
    v_max3_f32 v19, v16, v17, v18
    s_waitcnt lgkmcnt(0)
    v_max3_f32 v19, v19, v6, 0
    v_sub_f32 v72, v72, v19
    v_sub_f32 v92, v92, v19
    v_sub_f32 v36, v36, v19
    v_sub_f32 v73, v73, v19
    v_sub_f32 v93, v93, v19
    v_sub_f32 v37, v37, v19
    v_sub_f32 v74, v74, v19
    v_sub_f32 v94, v94, v19
    v_sub_f32 v38, v38, v19
    v_sub_f32 v75, v75, v19
    v_sub_f32 v95, v95, v19
    v_sub_f32 v39, v39, v19
    v_exp_f32 v6, -v19
    s_nop 0
    v_mul_f32 v15, v15, v6
    ds_write_b32 v7, v6 offset:528
    s_waitcnt lgkmcnt(0)
    s_nop 3
    s_branch L_qjoin_odd
L_qrare_even:
    s_nop 9
    v_and_b32 v7, 15, v1
    v_lshlrev_b32 v7, 5, v7
    v_add_u32 v7, 155648, v7
    s_lshl_b32 s26, s21, 9
    v_add_u32 v16, s26, v7
    v_max3_f32 v19, v76, v77, v78
    v_max_f32 v19, v19, v79
    v_mov_b32 v6, v19
    s_nop 1
    v_permlane32_swap_b32 v19, v6
    v_max_f32 v19, v19, v6
    v_mov_b32 v6, v19
    s_nop 1
    v_permlane16_swap_b32 v19, v6
    v_max_f32 v19, v19, v6
    ds_write_b32 v16, v19 offset:1536
    v_max3_f32 v19, v80, v81, v82
    v_max_f32 v19, v19, v83
    v_mov_b32 v6, v19
    s_nop 1
    v_permlane32_swap_b32 v19, v6
    v_max_f32 v19, v19, v6
    v_mov_b32 v6, v19
    s_nop 1
    v_permlane16_swap_b32 v19, v6
    v_max_f32 v19, v19, v6
    ds_write_b32 v16, v19 offset:1540
    v_max3_f32 v19, v84, v85, v86
    v_max_f32 v19, v19, v87
    v_mov_b32 v6, v19
    s_nop 1
    v_permlane32_swap_b32 v19, v6
    v_max_f32 v19, v19, v6
    v_mov_b32 v6, v19
    s_nop 1
    v_permlane16_swap_b32 v19, v6
    v_max_f32 v19, v19, v6
    ds_write_b32 v16, v19 offset:1544
    v_max3_f32 v19, v88, v89, v90
    v_max_f32 v19, v19, v91
    v_mov_b32 v6, v19
    s_nop 1
    v_permlane32_swap_b32 v19, v6
    v_max_f32 v19, v19, v6
    v_mov_b32 v6, v19
    s_nop 1
    v_permlane16_swap_b32 v19, v6
    v_max_f32 v19, v19, v6
    ds_write_b32 v16, v19 offset:1548
    v_max3_f32 v19, v92, v93, v94
    v_max_f32 v19, v19, v95
    v_mov_b32 v6, v19
    s_nop 1
    v_permlane32_swap_b32 v19, v6
    v_max_f32 v19, v19, v6
    v_mov_b32 v6, v19
    s_nop 1
    v_permlane16_swap_b32 v19, v6
    v_max_f32 v19, v19, v6
    ds_write_b32 v16, v19 offset:1552
    s_waitcnt lgkmcnt(0)
    s_barrier
    ds_read_b32 v16, v7 offset:1536
    ds_read_b32 v17, v7 offset:2048
    ds_read_b32 v18, v7 offset:2560
    ds_read_b32 v6, v7 offset:3072
    s_waitcnt lgkmcnt(1)
    v_max3_f32 v19, v16, v17, v18
    s_waitcnt lgkmcnt(0)
    v_max3_f32 v19, v19, v6, 0
    v_sub_f32 v76, v76, v19
    v_sub_f32 v56, v56, v19
    v_sub_f32 v20, v20, v19
    v_sub_f32 v77, v77, v19
    v_sub_f32 v57, v57, v19
    v_sub_f32 v21, v21, v19
    v_sub_f32 v78, v78, v19
    v_sub_f32 v58, v58, v19
    v_sub_f32 v22, v22, v19
    v_sub_f32 v79, v79, v19
    v_sub_f32 v59, v59, v19
    v_sub_f32 v23, v23, v19
    v_exp_f32 v6, -v19
    s_nop 0
    v_mul_f32 v11, v11, v6
    ds_write_b32 v7, v6 offset:1024
    ds_read_b32 v16, v7 offset:1540
    ds_read_b32 v17, v7 offset:2052
    ds_read_b32 v18, v7 offset:2564
    ds_read_b32 v6, v7 offset:3076
    s_waitcnt lgkmcnt(1)
    v_max3_f32 v19, v16, v17, v18
    s_waitcnt lgkmcnt(0)
    v_max3_f32 v19, v19, v6, 0
    v_sub_f32 v80, v80, v19
    v_sub_f32 v60, v60, v19
    v_sub_f32 v24, v24, v19
    v_sub_f32 v81, v81, v19
    v_sub_f32 v61, v61, v19
    v_sub_f32 v25, v25, v19
    v_sub_f32 v82, v82, v19
    v_sub_f32 v62, v62, v19
    v_sub_f32 v26, v26, v19
    v_sub_f32 v83, v83, v19
    v_sub_f32 v63, v63, v19
    v_sub_f32 v27, v27, v19
    v_exp_f32 v6, -v19
    s_nop 0
    v_mul_f32 v12, v12, v6
    ds_write_b32 v7, v6 offset:1028
    ds_read_b32 v16, v7 offset:1544
    ds_read_b32 v17, v7 offset:2056
    ds_read_b32 v18, v7 offset:2568
    ds_read_b32 v6, v7 offset:3080
    s_waitcnt lgkmcnt(1)
    v_max3_f32 v19, v16, v17, v18
    s_waitcnt lgkmcnt(0)
    v_max3_f32 v19, v19, v6, 0
    v_sub_f32 v84, v84, v19
    v_sub_f32 v64, v64, v19
    v_sub_f32 v28, v28, v19
    v_sub_f32 v85, v85, v19
    v_sub_f32 v65, v65, v19
    v_sub_f32 v29, v29, v19
    v_sub_f32 v86, v86, v19
    v_sub_f32 v66, v66, v19
    v_sub_f32 v30, v30, v19
    v_sub_f32 v87, v87, v19
    v_sub_f32 v67, v67, v19
    v_sub_f32 v31, v31, v19
    v_exp_f32 v6, -v19
    s_nop 0
    v_mul_f32 v13, v13, v6
    ds_write_b32 v7, v6 offset:1032
    ds_read_b32 v16, v7 offset:1548
    ds_read_b32 v17, v7 offset:2060
    ds_read_b32 v18, v7 offset:2572
    ds_read_b32 v6, v7 offset:3084
    s_waitcnt lgkmcnt(1)
    v_max3_f32 v19, v16, v17, v18
    s_waitcnt lgkmcnt(0)
    v_max3_f32 v19, v19, v6, 0
    v_sub_f32 v88, v88, v19
    v_sub_f32 v68, v68, v19
    v_sub_f32 v32, v32, v19
    v_sub_f32 v89, v89, v19
    v_sub_f32 v69, v69, v19
    v_sub_f32 v33, v33, v19
    v_sub_f32 v90, v90, v19
    v_sub_f32 v70, v70, v19
    v_sub_f32 v34, v34, v19
    v_sub_f32 v91, v91, v19
    v_sub_f32 v71, v71, v19
    v_sub_f32 v35, v35, v19
    v_exp_f32 v6, -v19
    s_nop 0
    v_mul_f32 v14, v14, v6
    ds_write_b32 v7, v6 offset:1036
    ds_read_b32 v16, v7 offset:1552
    ds_read_b32 v17, v7 offset:2064
    ds_read_b32 v18, v7 offset:2576
    ds_read_b32 v6, v7 offset:3088
    s_waitcnt lgkmcnt(1)
    v_max3_f32 v19, v16, v17, v18
    s_waitcnt lgkmcnt(0)
    v_max3_f32 v19, v19, v6, 0
    v_sub_f32 v92, v92, v19
    v_sub_f32 v72, v72, v19
    v_sub_f32 v36, v36, v19
    v_sub_f32 v93, v93, v19
    v_sub_f32 v73, v73, v19
    v_sub_f32 v37, v37, v19
    v_sub_f32 v94, v94, v19
    v_sub_f32 v74, v74, v19
    v_sub_f32 v38, v38, v19
    v_sub_f32 v95, v95, v19
    v_sub_f32 v75, v75, v19
    v_sub_f32 v39, v39, v19
    v_exp_f32 v6, -v19
    s_nop 0
    v_mul_f32 v15, v15, v6
    ds_write_b32 v7, v6 offset:1040
    s_waitcnt lgkmcnt(0)
    s_nop 3
    s_branch L_qjoin_even
L_qrare_p16:
    s_nop 9
    v_and_b32 v7, 15, v1
    v_lshlrev_b32 v7, 5, v7
    v_add_u32 v7, 155648, v7
    s_lshl_b32 s26, s21, 9
    v_add_u32 v16, s26, v7
    v_max3_f32 v19, v76, v77, v78
    v_max_f32 v19, v19, v79
    v_mov_b32 v6, v19
    s_nop 1
    v_permlane32_swap_b32 v19, v6
    v_max_f32 v19, v19, v6
    v_mov_b32 v6, v19
    s_nop 1
    v_permlane16_swap_b32 v19, v6
    v_max_f32 v19, v19, v6
    ds_write_b32 v16, v19 offset:1536
    v_max3_f32 v19, v80, v81, v82
    v_max_f32 v19, v19, v83
    v_mov_b32 v6, v19
    s_nop 1
    v_permlane32_swap_b32 v19, v6
    v_max_f32 v19, v19, v6
    v_mov_b32 v6, v19
    s_nop 1
    v_permlane16_swap_b32 v19, v6
    v_max_f32 v19, v19, v6
    ds_write_b32 v16, v19 offset:1540
    v_max3_f32 v19, v84, v85, v86
    v_max_f32 v19, v19, v87
    v_mov_b32 v6, v19
    s_nop 1
    v_permlane32_swap_b32 v19, v6
    v_max_f32 v19, v19, v6
    v_mov_b32 v6, v19
    s_nop 1
    v_permlane16_swap_b32 v19, v6
    v_max_f32 v19, v19, v6
    ds_write_b32 v16, v19 offset:1544
    v_max3_f32 v19, v88, v89, v90
    v_max_f32 v19, v19, v91
    v_mov_b32 v6, v19
    s_nop 1
    v_permlane32_swap_b32 v19, v6
    v_max_f32 v19, v19, v6
    v_mov_b32 v6, v19
    s_nop 1
    v_permlane16_swap_b32 v19, v6
    v_max_f32 v19, v19, v6
    ds_write_b32 v16, v19 offset:1548
    v_max3_f32 v19, v92, v93, v94
    v_max_f32 v19, v19, v95
    v_mov_b32 v6, v19
    s_nop 1
    v_permlane32_swap_b32 v19, v6
    v_max_f32 v19, v19, v6
    v_mov_b32 v6, v19
    s_nop 1
    v_permlane16_swap_b32 v19, v6
    v_max_f32 v19, v19, v6
    ds_write_b32 v16, v19 offset:1552
    s_waitcnt lgkmcnt(0)
    s_barrier
    ds_read_b32 v16, v7 offset:1536
    ds_read_b32 v17, v7 offset:2048
    ds_read_b32 v18, v7 offset:2560
    ds_read_b32 v6, v7 offset:3072
    s_waitcnt lgkmcnt(1)
    v_max3_f32 v19, v16, v17, v18
    s_waitcnt lgkmcnt(0)
    v_max3_f32 v19, v19, v6, 0
    v_sub_f32 v76, v76, v19
    v_sub_f32 v20, v20, v19
    v_sub_f32 v77, v77, v19
    v_sub_f32 v21, v21, v19
    v_sub_f32 v78, v78, v19
    v_sub_f32 v22, v22, v19
    v_sub_f32 v79, v79, v19
    v_sub_f32 v23, v23, v19
    v_exp_f32 v6, -v19
    s_nop 0
    v_mul_f32 v11, v11, v6
    ds_write_b32 v7, v6 offset:1024
    ds_read_b32 v16, v7 offset:1540
    ds_read_b32 v17, v7 offset:2052
    ds_read_b32 v18, v7 offset:2564
    ds_read_b32 v6, v7 offset:3076
    s_waitcnt lgkmcnt(1)
    v_max3_f32 v19, v16, v17, v18
    s_waitcnt lgkmcnt(0)
    v_max3_f32 v19, v19, v6, 0
    v_sub_f32 v80, v80, v19
    v_sub_f32 v24, v24, v19
    v_sub_f32 v81, v81, v19
    v_sub_f32 v25, v25, v19
    v_sub_f32 v82, v82, v19
    v_sub_f32 v26, v26, v19
    v_sub_f32 v83, v83, v19
    v_sub_f32 v27, v27, v19
    v_exp_f32 v6, -v19
    s_nop 0
    v_mul_f32 v12, v12, v6
    ds_write_b32 v7, v6 offset:1028
    ds_read_b32 v16, v7 offset:1544
    ds_read_b32 v17, v7 offset:2056
    ds_read_b32 v18, v7 offset:2568
    ds_read_b32 v6, v7 offset:3080
    s_waitcnt lgkmcnt(1)
    v_max3_f32 v19, v16, v17, v18
    s_waitcnt lgkmcnt(0)
    v_max3_f32 v19, v19, v6, 0
    v_sub_f32 v84, v84, v19
    v_sub_f32 v28, v28, v19
    v_sub_f32 v85, v85, v19
    v_sub_f32 v29, v29, v19
    v_sub_f32 v86, v86, v19
    v_sub_f32 v30, v30, v19
    v_sub_f32 v87, v87, v19
    v_sub_f32 v31, v31, v19
    v_exp_f32 v6, -v19
    s_nop 0
    v_mul_f32 v13, v13, v6
    ds_write_b32 v7, v6 offset:1032
    ds_read_b32 v16, v7 offset:1548
    ds_read_b32 v17, v7 offset:2060
    ds_read_b32 v18, v7 offset:2572
    ds_read_b32 v6, v7 offset:3084
    s_waitcnt lgkmcnt(1)
    v_max3_f32 v19, v16, v17, v18
    s_waitcnt lgkmcnt(0)
    v_max3_f32 v19, v19, v6, 0
    v_sub_f32 v88, v88, v19
    v_sub_f32 v32, v32, v19
    v_sub_f32 v89, v89, v19
    v_sub_f32 v33, v33, v19
    v_sub_f32 v90, v90, v19
    v_sub_f32 v34, v34, v19
    v_sub_f32 v91, v91, v19
    v_sub_f32 v35, v35, v19
    v_exp_f32 v6, -v19
    s_nop 0
    v_mul_f32 v14, v14, v6
    ds_write_b32 v7, v6 offset:1036
    ds_read_b32 v16, v7 offset:1552
    ds_read_b32 v17, v7 offset:2064
    ds_read_b32 v18, v7 offset:2576
    ds_read_b32 v6, v7 offset:3088
    s_waitcnt lgkmcnt(1)
    v_max3_f32 v19, v16, v17, v18
    s_waitcnt lgkmcnt(0)
    v_max3_f32 v19, v19, v6, 0
    v_sub_f32 v92, v92, v19
    v_sub_f32 v36, v36, v19
    v_sub_f32 v93, v93, v19
    v_sub_f32 v37, v37, v19
    v_sub_f32 v94, v94, v19
    v_sub_f32 v38, v38, v19
    v_sub_f32 v95, v95, v19
    v_sub_f32 v39, v39, v19
    v_exp_f32 v6, -v19
    s_nop 0
    v_mul_f32 v15, v15, v6
    ds_write_b32 v7, v6 offset:1040
    s_waitcnt lgkmcnt(0)
    s_nop 3
    s_branch L_qjoin_p16
L_pv:
    s_cmp_ge_u32 s2, 16
    s_cbranch_scc1 L_nocpf
    s_getpc_b64 s[96:97]
L_pcref:
    s_sub_u32 s96, s96, L_pcref-standalone__gqa_block_cached__near_ridge_kernel
    s_subb_u32 s97, s97, 0
    s_lshl_b32 s26, s21, 13
    v_lshlrev_b32 v2, 7, v1
    v_add_u32 v2, s26, v2
    v_min_u32 v2, L_code_end-standalone__gqa_block_cached__near_ridge_kernel-4, v2
    global_load_dword v16, v2, s[96:97]
L_nocpf:
    v_lshrrev_b32 v17, 4, v1
    v_lshlrev_b32 v17, 10, v17
    v_bfe_u32 v18, v1, 2, 2
    v_lshlrev_b32 v18, 7, v18
    v_add_u32 v17, v17, v18
    v_and_b32 v18, 3, v1
    v_lshlrev_b32 v18, 3, v18
    v_add_u32 v17, v17, v18
    v_bfe_u32 v18, v1, 3, 2
    v_lshlrev_b32 v18, 5, v18
    v_add_u32 v19, v17, v18
    v_and_b32 v17, 15, v1
    v_and_b32 v18, 7, v1
    v_lshlrev_b32 v17, 7, v17
    v_lshrrev_b32 v6, 4, v1
    v_xor_b32 v18, v18, v6
    v_lshlrev_b32 v18, 4, v18
    v_add_u32 v6, v17, v18
    v_xor_b32 v7, 64, v6
    v_mov_b32 v20, v6
    v_bfe_u32 v17, v1, 4, 1
    v_lshrrev_b32 v18, 5, v1
    v_lshl_add_u32 v17, v17, 1, v18
    v_and_b32 v18, 7, v1
    v_xor_b32 v17, v17, v18
    v_lshlrev_b32 v17, 4, v17
    v_and_b32 v18, 15, v1
    v_lshl_add_u32 v17, v18, 7, v17
    s_lshl_b32 s26, s21, 11
    v_add_u32 v21, s26, v17
    v_mov_b32 v176, 0
    v_mov_b32 v177, 0
    v_mov_b32 v178, 0
    v_mov_b32 v179, 0
    v_mov_b32 v180, 0
    v_mov_b32 v181, 0
    v_mov_b32 v182, 0
    v_mov_b32 v183, 0
    v_mov_b32 v184, 0
    v_mov_b32 v185, 0
    v_mov_b32 v186, 0
    v_mov_b32 v187, 0
    v_mov_b32 v188, 0
    v_mov_b32 v189, 0
    v_mov_b32 v190, 0
    v_mov_b32 v191, 0
    v_mov_b32 v192, 0
    v_mov_b32 v193, 0
    v_mov_b32 v194, 0
    v_mov_b32 v195, 0
    v_mov_b32 v196, 0
    v_mov_b32 v197, 0
    v_mov_b32 v198, 0
    v_mov_b32 v199, 0
    v_mov_b32 v200, 0
    v_mov_b32 v201, 0
    v_mov_b32 v202, 0
    v_mov_b32 v203, 0
    v_mov_b32 v204, 0
    v_mov_b32 v205, 0
    v_mov_b32 v206, 0
    v_mov_b32 v207, 0
    v_mov_b32 v208, 0
    v_mov_b32 v209, 0
    v_mov_b32 v210, 0
    v_mov_b32 v211, 0
    v_mov_b32 v212, 0
    v_mov_b32 v213, 0
    v_mov_b32 v214, 0
    v_mov_b32 v215, 0
    v_mov_b32 v216, 0
    v_mov_b32 v217, 0
    v_mov_b32 v218, 0
    v_mov_b32 v219, 0
    v_mov_b32 v220, 0
    v_mov_b32 v221, 0
    v_mov_b32 v222, 0
    v_mov_b32 v223, 0
    v_mov_b32 v224, 0
    v_mov_b32 v225, 0
    v_mov_b32 v226, 0
    v_mov_b32 v227, 0
    v_mov_b32 v228, 0
    v_mov_b32 v229, 0
    v_mov_b32 v230, 0
    v_mov_b32 v231, 0
    v_mov_b32 v232, 0
    v_mov_b32 v233, 0
    v_mov_b32 v234, 0
    v_mov_b32 v235, 0
    v_mov_b32 v236, 0
    v_mov_b32 v237, 0
    v_mov_b32 v238, 0
    v_mov_b32 v239, 0
    v_mov_b32 v240, 0
    v_mov_b32 v241, 0
    v_mov_b32 v242, 0
    v_mov_b32 v243, 0
    v_mov_b32 v244, 0
    v_mov_b32 v245, 0
    v_mov_b32 v246, 0
    v_mov_b32 v247, 0
    v_mov_b32 v248, 0
    v_mov_b32 v249, 0
    v_mov_b32 v250, 0
    v_mov_b32 v251, 0
    v_mov_b32 v252, 0
    v_mov_b32 v253, 0
    v_mov_b32 v254, 0
    v_mov_b32 v255, 0
    s_waitcnt lgkmcnt(0)
    s_mul_i32 s26, s24, 229376
    s_add_u32 s44, s12, s26
    s_addc_u32 s45, s13, 0
    s_mov_b32 s46, 229376
    s_mov_b32 s47, 0x20000
    s_lshl_b32 s26, s25, 4
    s_add_u32 s26, s26, s24
    s_mul_i32 s26, s26, 71680
    s_add_u32 s48, s18, s26
    s_addc_u32 s49, s19, 0
    s_mov_b32 s50, 71680
    s_mov_b32 s51, 0x20000
    s_mul_i32 s26, s25, 4352
    s_add_u32 s26, s26, 67108864
    s_add_u32 s92, s18, s26
    s_addc_u32 s93, s19, 0
    s_mov_b32 s94, 128
    s_mov_b32 s95, 0x20000
    s_lshl_b32 s26, s22, 3
    s_add_u32 s26, s26, s23
    s_lshl_b32 s28, s26, 19
    s_add_u32 s32, s8, s28
    s_addc_u32 s33, s9, 0
    s_mov_b32 s34, 524288
    s_mov_b32 s35, 0x20000
    s_mov_b32 s84, s16
    s_mov_b32 s85, s17
    s_mov_b32 s86, 256
    s_mov_b32 s87, 0x20000
    s_add_u32 s58, s21, 4
    v_lshlrev_b32 v14, 8, v1
    s_cmp_lg_u32 s20, 7
    s_cbranch_scc1 L_noclr
    v_mov_b32 v13, 0
    s_lshl_b32 s26, s24, 2
    buffer_store_dword v13, v14, s[92:95], s26 offen sc1
    buffer_store_dword v13, v14, s[92:95], s26 offen offset:64 sc1
L_noclr:
    s_lshl_b32 s26, s25, 2
    s_add_u32 s26, s26, s21
    s_mul_i32 s82, s26, 3584
    s_mov_b32 s30, 0x3db8aa3b
    s_mov_b32 s31, 0x3db8aa3b
    s_lshl_b32 s26, s21, 13
    s_add_u32 s55, s26, 65536
    s_add_u32 s65, s26, 98304
    s_add_u32 s66, s26, 65536
    s_add_u32 s67, s26, 32768
    s_mov_b32 s68, 131072
    s_mov_b32 s69, 141312
    s_mov_b32 s70, 151552
    s_mov_b32 s56, 0
    v_lshrrev_b32 v17, 3, v1
    v_and_b32 v17, 2, v17
    v_and_b32 v18, 7, v1
    v_xor_b32 v17, v17, v18
    v_lshlrev_b32 v17, 4, v17
    v_lshrrev_b32 v18, 3, v1
    v_mul_u32_u24 v18, 512, v18
    v_add_u32 v8, v17, v18
    v_xor_b32 v17, 64, v17
    v_add_u32 v9, v17, v18
    v_add_u32 v9, 3072, v9
    s_lshl_b32 s57, s21, 7
    s_bfe_u32 s26, s2, 0x40003
    s_mov_b32 s90, 0x76543210
    s_mov_b32 s91, 0xfedcba98
    s_cmp_eq_u32 s26, 1
    s_cselect_b32 s90, 0x87354021, s90
    s_cselect_b32 s91, 0xfced9ba6, s91
    s_cmp_eq_u32 s26, 2
    s_cselect_b32 s90, 0x68435102, s90
    s_cselect_b32 s91, 0xfdcea9b7, s91
    s_cmp_eq_u32 s26, 3
    s_cselect_b32 s90, 0x68354210, s90
    s_cselect_b32 s91, 0xfcedba97, s91
    s_cmp_eq_u32 s26, 4
    s_cselect_b32 s90, 0x87654321, s90
    s_cselect_b32 s91, 0xfedcba9, s91
    s_cmp_eq_u32 s26, 5
    s_cselect_b32 s90, 0x68735402, s90
    s_cselect_b32 s91, 0x1fced9ba, s91
    s_cmp_eq_u32 s26, 6
    s_cselect_b32 s90, 0x76843510, s90
    s_cselect_b32 s91, 0x2fdcea9b, s91
    s_cmp_eq_u32 s26, 7
    s_cselect_b32 s90, 0x76835421, s90
    s_cselect_b32 s91, 0xfcedba9, s91
    s_cmp_eq_u32 s26, 8
    s_cselect_b32 s90, 0x98765432, s90
    s_cselect_b32 s91, 0x10fedcba, s91
    s_cmp_eq_u32 s26, 9
    s_cselect_b32 s90, 0xa6873540, s90
    s_cselect_b32 s91, 0x21fced9b, s91
    s_cmp_eq_u32 s26, 10
    s_cselect_b32 s90, 0xb7684351, s90
    s_cselect_b32 s91, 0x2fdcea9, s91
    s_cmp_eq_u32 s26, 11
    s_cselect_b32 s90, 0x97683542, s90
    s_cselect_b32 s91, 0x10fcedba, s91
    s_cmp_eq_u32 s26, 13
    s_cselect_b32 s90, 0x87354021, s90
    s_cselect_b32 s91, 0xfced9ba6, s91
    s_cmp_eq_u32 s26, 14
    s_cselect_b32 s90, 0x68435102, s90
    s_cselect_b32 s91, 0xfdcea9b7, s91
    s_cmp_eq_u32 s26, 15
    s_cselect_b32 s90, 0x68354210, s90
    s_cselect_b32 s91, 0xfcedba97, s91
    s_mov_b32 s54, 32768
    s_and_b32 s52, s90, 15
    s_lshr_b64 s[90:91], s[90:91], 4
    s_mul_i32 s52, s52, s54
    s_add_u32 s52, s52, s57
    s_and_b32 s52, s90, 15
    s_lshr_b64 s[90:91], s[90:91], 4
    s_mul_i32 s52, s52, s54
    s_add_u32 s52, s52, s57
    s_mov_b32 s53, 8192
    v_mov_b32 v10, 155648
    v_and_b32 v11, 15, v1
    v_lshlrev_b32 v11, 5, v11
    v_add_u32 v11, 155648, v11
    s_mov_b32 s80, 0
    s_mov_b32 s81, 0
    v_add_u32 v2, s65, v19
    v_xor_b32 v3, 32, v2
    v_xor_b32 v4, 64, v2
    v_xor_b32 v5, 96, v2
    v_add_u32 v6, s68, v20
    v_xor_b32 v7, 64, v6
    s_mov_b32 s26, s65
    s_mov_b32 s65, s66
    s_mov_b32 s66, s67
    s_mov_b32 s67, s26
    s_mov_b32 s26, s68
    s_mov_b32 s68, s69
    s_mov_b32 s69, s70
    s_mov_b32 s70, s26
    s_barrier
    ds_read_b64_tr_b16 v[112:113], v2 offset:0
    ds_read_b64_tr_b16 v[114:115], v2 offset:512
    ds_read_b128 v[72:75], v6 offset:0
    ds_read_b128 v[76:79], v6 offset:2048
    ds_read_b128 v[80:83], v6 offset:4096
    ds_read_b128 v[84:87], v6 offset:6144
    ds_read_b128 v[88:91], v6 offset:8192
    ds_read_b64_tr_b16 v[116:117], v3 offset:0
    ds_read_b64_tr_b16 v[118:119], v3 offset:512
    ds_read_b64_tr_b16 v[120:121], v4 offset:0
    ds_read_b64_tr_b16 v[122:123], v4 offset:512
    ds_read_b64_tr_b16 v[124:125], v5 offset:0
    ds_read_b64_tr_b16 v[126:127], v5 offset:512
L_qproj:
    s_waitcnt lgkmcnt(10)
    v_mfma_f32_16x16x32_bf16 v[176:179], v[112:115], v[72:75], v[176:179]
    s_waitcnt lgkmcnt(9)
    v_mfma_f32_16x16x32_bf16 v[180:183], v[112:115], v[76:79], v[180:183]
    ds_read_b128 v[92:95], v7 offset:0
    ds_read_b128 v[96:99], v7 offset:2048
    s_waitcnt lgkmcnt(10)
    v_mfma_f32_16x16x32_bf16 v[184:187], v[112:115], v[80:83], v[184:187]
    ds_read_b128 v[100:103], v7 offset:4096
    ds_read_b128 v[104:107], v7 offset:6144
    s_waitcnt lgkmcnt(11)
    v_mfma_f32_16x16x32_bf16 v[188:191], v[112:115], v[84:87], v[188:191]
    ds_read_b128 v[108:111], v7 offset:8192
    s_waitcnt lgkmcnt(11)
    v_mfma_f32_16x16x32_bf16 v[192:195], v[112:115], v[88:91], v[192:195]
    ds_read_b64_tr_b16 v[128:129], v2 offset:4096
    ds_read_b64_tr_b16 v[130:131], v2 offset:4608
    s_waitcnt lgkmcnt(11)
    v_mfma_f32_16x16x32_bf16 v[196:199], v[116:119], v[72:75], v[196:199]
    ds_read_b64_tr_b16 v[132:133], v3 offset:4096
    ds_read_b64_tr_b16 v[134:135], v3 offset:4608
    v_mfma_f32_16x16x32_bf16 v[200:203], v[116:119], v[76:79], v[200:203]
    ds_read_b64_tr_b16 v[136:137], v4 offset:4096
    v_mfma_f32_16x16x32_bf16 v[204:207], v[116:119], v[80:83], v[204:207]
    ds_read_b64_tr_b16 v[138:139], v4 offset:4608
    s_waitcnt lgkmcnt(14)
    ds_read_b64_tr_b16 v[140:141], v5 offset:4096
    v_mfma_f32_16x16x32_bf16 v[208:211], v[116:119], v[84:87], v[208:211]
    s_waitcnt lgkmcnt(14)
    ds_read_b64_tr_b16 v[142:143], v5 offset:4608
    v_mfma_f32_16x16x32_bf16 v[212:215], v[116:119], v[88:91], v[212:215]
    v_mfma_f32_16x16x32_bf16 v[216:219], v[120:123], v[72:75], v[216:219]
    v_mfma_f32_16x16x32_bf16 v[220:223], v[120:123], v[76:79], v[220:223]
    v_mfma_f32_16x16x32_bf16 v[224:227], v[120:123], v[80:83], v[224:227]
    v_add_u32 v2, s65, v19
    v_xor_b32 v3, 32, v2
    v_mfma_f32_16x16x32_bf16 v[228:231], v[120:123], v[84:87], v[228:231]
    v_xor_b32 v4, 64, v2
    v_xor_b32 v5, 96, v2
    v_mfma_f32_16x16x32_bf16 v[232:235], v[120:123], v[88:91], v[232:235]
    v_add_u32 v6, s68, v20
    v_xor_b32 v7, 64, v6
    s_waitcnt lgkmcnt(13)
    v_mfma_f32_16x16x32_bf16 v[236:239], v[124:127], v[72:75], v[236:239]
    s_mov_b32 s26, s65
    s_mov_b32 s65, s66
    v_mfma_f32_16x16x32_bf16 v[240:243], v[124:127], v[76:79], v[240:243]
    s_mov_b32 s66, s67
    s_mov_b32 s67, s26
    v_mfma_f32_16x16x32_bf16 v[244:247], v[124:127], v[80:83], v[244:247]
    s_mov_b32 s26, s68
    s_mov_b32 s68, s69
    v_mfma_f32_16x16x32_bf16 v[248:251], v[124:127], v[84:87], v[248:251]
    s_mov_b32 s69, s70
    s_mov_b32 s70, s26
    v_mfma_f32_16x16x32_bf16 v[252:255], v[124:127], v[88:91], v[252:255]
    s_add_u32 s56, s56, 1
    s_waitcnt lgkmcnt(0)
    s_barrier
    s_cmp_eq_u32 s56, 7
    s_cbranch_scc1 L_qproj_last
    v_mfma_f32_16x16x32_bf16 v[176:179], v[128:131], v[92:95], v[176:179]
    ds_read_b64_tr_b16 v[112:113], v2 offset:0
    ds_read_b64_tr_b16 v[114:115], v2 offset:512
    v_mfma_f32_16x16x32_bf16 v[180:183], v[128:131], v[96:99], v[180:183]
    ds_read_b128 v[72:75], v6 offset:0
    v_mfma_f32_16x16x32_bf16 v[184:187], v[128:131], v[100:103], v[184:187]
    ds_read_b128 v[76:79], v6 offset:2048
    v_mfma_f32_16x16x32_bf16 v[188:191], v[128:131], v[104:107], v[188:191]
    ds_read_b128 v[80:83], v6 offset:4096
    ds_read_b128 v[84:87], v6 offset:6144
    v_mfma_f32_16x16x32_bf16 v[192:195], v[128:131], v[108:111], v[192:195]
    ds_read_b128 v[88:91], v6 offset:8192
    v_mfma_f32_16x16x32_bf16 v[196:199], v[132:135], v[92:95], v[196:199]
    ds_read_b64_tr_b16 v[116:117], v3 offset:0
    v_mfma_f32_16x16x32_bf16 v[200:203], v[132:135], v[96:99], v[200:203]
    ds_read_b64_tr_b16 v[118:119], v3 offset:512
    ds_read_b64_tr_b16 v[120:121], v4 offset:0
    v_mfma_f32_16x16x32_bf16 v[204:207], v[132:135], v[100:103], v[204:207]
    ds_read_b64_tr_b16 v[122:123], v4 offset:512
    v_mfma_f32_16x16x32_bf16 v[208:211], v[132:135], v[104:107], v[208:211]
    ds_read_b64_tr_b16 v[124:125], v5 offset:0
    v_mfma_f32_16x16x32_bf16 v[212:215], v[132:135], v[108:111], v[212:215]
    ds_read_b64_tr_b16 v[126:127], v5 offset:512
    v_mfma_f32_16x16x32_bf16 v[216:219], v[136:139], v[92:95], v[216:219]
    v_mfma_f32_16x16x32_bf16 v[220:223], v[136:139], v[96:99], v[220:223]
    v_mfma_f32_16x16x32_bf16 v[224:227], v[136:139], v[100:103], v[224:227]
    v_mfma_f32_16x16x32_bf16 v[228:231], v[136:139], v[104:107], v[228:231]
    v_mfma_f32_16x16x32_bf16 v[232:235], v[136:139], v[108:111], v[232:235]
    v_mfma_f32_16x16x32_bf16 v[236:239], v[140:143], v[92:95], v[236:239]
    v_mfma_f32_16x16x32_bf16 v[240:243], v[140:143], v[96:99], v[240:243]
    v_mfma_f32_16x16x32_bf16 v[244:247], v[140:143], v[100:103], v[244:247]
    v_mfma_f32_16x16x32_bf16 v[248:251], v[140:143], v[104:107], v[248:251]
    v_mfma_f32_16x16x32_bf16 v[252:255], v[140:143], v[108:111], v[252:255]
    s_branch L_qproj
L_qproj_last:
    v_add_u32 v22, 98304, v21
    v_xor_b32 v23, 64, v22
    v_mov_b32 v12, 0
    v_mov_b32 v13, 0
    v_mfma_f32_16x16x32_bf16 v[176:179], v[128:131], v[92:95], v[176:179]
    v_mfma_f32_16x16x32_bf16 v[196:199], v[132:135], v[92:95], v[196:199]
    ds_write_b64 v10, v[12:13]
    v_mfma_f32_16x16x32_bf16 v[180:183], v[128:131], v[96:99], v[180:183]
    v_mfma_f32_16x16x32_bf16 v[200:203], v[132:135], v[96:99], v[200:203]
    v_mfma_f32_16x16x32_bf16 v[184:187], v[128:131], v[100:103], v[184:187]
    s_nop 2
    v_mul_f32 v176, s30, v176
    v_mul_f32 v177, s30, v177
    v_mul_f32 v178, s30, v178
    v_mul_f32 v179, s30, v179
    v_mul_f32 v196, s30, v196
    v_mul_f32 v197, s30, v197
    v_mul_f32 v198, s30, v198
    v_mul_f32 v199, s30, v199
    v_cvt_pk_bf16_f32 v176, v176, v177
    v_cvt_pk_bf16_f32 v177, v178, v179
    v_cvt_pk_bf16_f32 v178, v196, v197
    v_cvt_pk_bf16_f32 v179, v198, v199
    s_nop 0
    v_permlane16_swap_b32 v176, v178
    v_permlane16_swap_b32 v177, v179
    ds_write_b128 v22, v[176:179] offset:0
    v_mfma_f32_16x16x32_bf16 v[204:207], v[132:135], v[100:103], v[204:207]
    v_mfma_f32_16x16x32_bf16 v[188:191], v[128:131], v[104:107], v[188:191]
    v_mul_f32 v180, s30, v180
    v_mul_f32 v181, s30, v181
    v_mul_f32 v182, s30, v182
    v_mul_f32 v183, s30, v183
    v_mul_f32 v200, s30, v200
    v_mul_f32 v201, s30, v201
    v_mul_f32 v202, s30, v202
    v_mul_f32 v203, s30, v203
    v_cvt_pk_bf16_f32 v180, v180, v181
    v_cvt_pk_bf16_f32 v181, v182, v183
    v_cvt_pk_bf16_f32 v182, v200, v201
    v_cvt_pk_bf16_f32 v183, v202, v203
    s_nop 0
    v_permlane16_swap_b32 v180, v182
    v_permlane16_swap_b32 v181, v183
    ds_write_b128 v22, v[180:183] offset:8192
    v_mfma_f32_16x16x32_bf16 v[208:211], v[132:135], v[104:107], v[208:211]
    v_mfma_f32_16x16x32_bf16 v[192:195], v[128:131], v[108:111], v[192:195]
    v_mul_f32 v184, s30, v184
    v_mul_f32 v185, s30, v185
    v_mul_f32 v186, s30, v186
    v_mul_f32 v187, s30, v187
    v_mul_f32 v204, s30, v204
    v_mul_f32 v205, s30, v205
    v_mul_f32 v206, s30, v206
    v_mul_f32 v207, s30, v207
    v_cvt_pk_bf16_f32 v184, v184, v185
    v_cvt_pk_bf16_f32 v185, v186, v187
    v_cvt_pk_bf16_f32 v186, v204, v205
    v_cvt_pk_bf16_f32 v187, v206, v207
    s_nop 0
    v_permlane16_swap_b32 v184, v186
    v_permlane16_swap_b32 v185, v187
    ds_write_b128 v22, v[184:187] offset:16384
    v_mfma_f32_16x16x32_bf16 v[212:215], v[132:135], v[108:111], v[212:215]
    v_mfma_f32_16x16x32_bf16 v[216:219], v[136:139], v[92:95], v[216:219]
    v_mul_f32 v188, s30, v188
    v_mul_f32 v189, s30, v189
    v_mul_f32 v190, s30, v190
    v_mul_f32 v191, s30, v191
    v_mul_f32 v208, s30, v208
    v_mul_f32 v209, s30, v209
    v_mul_f32 v210, s30, v210
    v_mul_f32 v211, s30, v211
    v_cvt_pk_bf16_f32 v188, v188, v189
    v_cvt_pk_bf16_f32 v189, v190, v191
    v_cvt_pk_bf16_f32 v190, v208, v209
    v_cvt_pk_bf16_f32 v191, v210, v211
    s_nop 0
    v_permlane16_swap_b32 v188, v190
    v_permlane16_swap_b32 v189, v191
    ds_write_b128 v22, v[188:191] offset:24576
    v_mfma_f32_16x16x32_bf16 v[236:239], v[140:143], v[92:95], v[236:239]
    v_mfma_f32_16x16x32_bf16 v[220:223], v[136:139], v[96:99], v[220:223]
    v_mul_f32 v192, s30, v192
    v_mul_f32 v193, s30, v193
    v_mul_f32 v194, s30, v194
    v_mul_f32 v195, s30, v195
    v_mul_f32 v212, s30, v212
    v_mul_f32 v213, s30, v213
    v_mul_f32 v214, s30, v214
    v_mul_f32 v215, s30, v215
    v_cvt_pk_bf16_f32 v192, v192, v193
    v_cvt_pk_bf16_f32 v193, v194, v195
    v_cvt_pk_bf16_f32 v194, v212, v213
    v_cvt_pk_bf16_f32 v195, v214, v215
    s_nop 0
    v_permlane16_swap_b32 v192, v194
    v_permlane16_swap_b32 v193, v195
    ds_write_b128 v22, v[192:195] offset:32768
    v_mfma_f32_16x16x32_bf16 v[240:243], v[140:143], v[96:99], v[240:243]
    v_mfma_f32_16x16x32_bf16 v[224:227], v[136:139], v[100:103], v[224:227]
    v_mul_f32 v216, s30, v216
    v_mul_f32 v217, s30, v217
    v_mul_f32 v218, s30, v218
    v_mul_f32 v219, s30, v219
    v_mul_f32 v236, s30, v236
    v_mul_f32 v237, s30, v237
    v_mul_f32 v238, s30, v238
    v_mul_f32 v239, s30, v239
    v_cvt_pk_bf16_f32 v216, v216, v217
    v_cvt_pk_bf16_f32 v217, v218, v219
    v_cvt_pk_bf16_f32 v218, v236, v237
    v_cvt_pk_bf16_f32 v219, v238, v239
    s_nop 0
    v_permlane16_swap_b32 v216, v218
    v_permlane16_swap_b32 v217, v219
    ds_write_b128 v23, v[216:219] offset:0
    v_mfma_f32_16x16x32_bf16 v[244:247], v[140:143], v[100:103], v[244:247]
    v_mfma_f32_16x16x32_bf16 v[228:231], v[136:139], v[104:107], v[228:231]
    v_mul_f32 v220, s30, v220
    v_mul_f32 v221, s30, v221
    v_mul_f32 v222, s30, v222
    v_mul_f32 v223, s30, v223
    v_mul_f32 v240, s30, v240
    v_mul_f32 v241, s30, v241
    v_mul_f32 v242, s30, v242
    v_mul_f32 v243, s30, v243
    v_cvt_pk_bf16_f32 v220, v220, v221
    v_cvt_pk_bf16_f32 v221, v222, v223
    v_cvt_pk_bf16_f32 v222, v240, v241
    v_cvt_pk_bf16_f32 v223, v242, v243
    s_nop 0
    v_permlane16_swap_b32 v220, v222
    v_permlane16_swap_b32 v221, v223
    ds_write_b128 v23, v[220:223] offset:8192
    v_mfma_f32_16x16x32_bf16 v[248:251], v[140:143], v[104:107], v[248:251]
    v_mfma_f32_16x16x32_bf16 v[232:235], v[136:139], v[108:111], v[232:235]
    v_mul_f32 v224, s30, v224
    v_mul_f32 v225, s30, v225
    v_mul_f32 v226, s30, v226
    v_mul_f32 v227, s30, v227
    v_mul_f32 v244, s30, v244
    v_mul_f32 v245, s30, v245
    v_mul_f32 v246, s30, v246
    v_mul_f32 v247, s30, v247
    v_cvt_pk_bf16_f32 v224, v224, v225
    v_cvt_pk_bf16_f32 v225, v226, v227
    v_cvt_pk_bf16_f32 v226, v244, v245
    v_cvt_pk_bf16_f32 v227, v246, v247
    s_nop 0
    v_permlane16_swap_b32 v224, v226
    v_permlane16_swap_b32 v225, v227
    ds_write_b128 v23, v[224:227] offset:16384
    v_mfma_f32_16x16x32_bf16 v[252:255], v[140:143], v[108:111], v[252:255]
    v_mul_f32 v228, s30, v228
    v_mul_f32 v229, s30, v229
    v_mul_f32 v230, s30, v230
    v_mul_f32 v231, s30, v231
    v_mul_f32 v248, s30, v248
    v_mul_f32 v249, s30, v249
    v_mul_f32 v250, s30, v250
    v_mul_f32 v251, s30, v251
    v_cvt_pk_bf16_f32 v228, v228, v229
    v_cvt_pk_bf16_f32 v229, v230, v231
    v_cvt_pk_bf16_f32 v230, v248, v249
    v_cvt_pk_bf16_f32 v231, v250, v251
    s_nop 0
    v_permlane16_swap_b32 v228, v230
    v_permlane16_swap_b32 v229, v231
    ds_write_b128 v23, v[228:231] offset:24576
    v_mul_f32 v232, s30, v232
    v_mul_f32 v233, s30, v233
    v_mul_f32 v234, s30, v234
    v_mul_f32 v235, s30, v235
    v_mul_f32 v252, s30, v252
    v_mul_f32 v253, s30, v253
    v_mul_f32 v254, s30, v254
    v_mul_f32 v255, s30, v255
    v_cvt_pk_bf16_f32 v232, v232, v233
    v_cvt_pk_bf16_f32 v233, v234, v235
    v_cvt_pk_bf16_f32 v234, v252, v253
    v_cvt_pk_bf16_f32 v235, v254, v255
    s_nop 0
    v_permlane16_swap_b32 v232, v234
    v_permlane16_swap_b32 v233, v235
    ds_write_b128 v23, v[232:235] offset:32768
    s_waitcnt lgkmcnt(0)
    s_barrier
    s_cmp_lg_u32 s20, 7
    s_cbranch_scc1 L_noclr2
    s_lshl_b32 s26, 1, s24
    v_mov_b32 v13, s26
    s_lshl_b32 s26, s25, 4
    s_waitcnt vmcnt(0)
    buffer_atomic_or v13, v14, s[84:87], s26 offen sc1
L_noclr2:
    v_add_u32 v2, s55, v19
    v_xor_b32 v3, 32, v2
    v_xor_b32 v4, 64, v2
    v_xor_b32 v5, 96, v2
    v_add_u32 v6, 131072, v20
    v_xor_b32 v7, 64, v6
    v_mov_b32 v176, 0
    v_mov_b32 v177, 0
    v_mov_b32 v178, 0
    v_mov_b32 v179, 0
    v_mov_b32 v180, 0
    v_mov_b32 v181, 0
    v_mov_b32 v182, 0
    v_mov_b32 v183, 0
    v_mov_b32 v184, 0
    v_mov_b32 v185, 0
    v_mov_b32 v186, 0
    v_mov_b32 v187, 0
    v_mov_b32 v188, 0
    v_mov_b32 v189, 0
    v_mov_b32 v190, 0
    v_mov_b32 v191, 0
    v_mov_b32 v192, 0
    v_mov_b32 v193, 0
    v_mov_b32 v194, 0
    v_mov_b32 v195, 0
    v_mov_b32 v196, 0
    v_mov_b32 v197, 0
    v_mov_b32 v198, 0
    v_mov_b32 v199, 0
    v_mov_b32 v200, 0
    v_mov_b32 v201, 0
    v_mov_b32 v202, 0
    v_mov_b32 v203, 0
    v_mov_b32 v204, 0
    v_mov_b32 v205, 0
    v_mov_b32 v206, 0
    v_mov_b32 v207, 0
    v_mov_b32 v208, 0
    v_mov_b32 v209, 0
    v_mov_b32 v210, 0
    v_mov_b32 v211, 0
    v_mov_b32 v212, 0
    v_mov_b32 v213, 0
    v_mov_b32 v214, 0
    v_mov_b32 v215, 0
    v_mov_b32 v216, 0
    v_mov_b32 v217, 0
    v_mov_b32 v218, 0
    v_mov_b32 v219, 0
    v_mov_b32 v220, 0
    v_mov_b32 v221, 0
    v_mov_b32 v222, 0
    v_mov_b32 v223, 0
    v_mov_b32 v224, 0
    v_mov_b32 v225, 0
    v_mov_b32 v226, 0
    v_mov_b32 v227, 0
    v_mov_b32 v228, 0
    v_mov_b32 v229, 0
    v_mov_b32 v230, 0
    v_mov_b32 v231, 0
    v_mov_b32 v232, 0
    v_mov_b32 v233, 0
    v_mov_b32 v234, 0
    v_mov_b32 v235, 0
    v_mov_b32 v236, 0
    v_mov_b32 v237, 0
    v_mov_b32 v238, 0
    v_mov_b32 v239, 0
    v_mov_b32 v240, 0
    v_mov_b32 v241, 0
    v_mov_b32 v242, 0
    v_mov_b32 v243, 0
    v_mov_b32 v244, 0
    v_mov_b32 v245, 0
    v_mov_b32 v246, 0
    v_mov_b32 v247, 0
    v_mov_b32 v248, 0
    v_mov_b32 v249, 0
    v_mov_b32 v250, 0
    v_mov_b32 v251, 0
    v_mov_b32 v252, 0
    v_mov_b32 v253, 0
    v_mov_b32 v254, 0
    v_mov_b32 v255, 0
    s_barrier
    s_add_u32 m0, s55, 32768
    s_nop 0
    buffer_load_dwordx4 v8, s[32:35], s52 offen lds
    buffer_load_dwordx4 v9, s[32:35], s52 offen offset:1024 lds
    s_add_u32 s52, s52, s53
    s_add_u32 m0, s55, 34816
    s_nop 0
    buffer_load_dwordx4 v8, s[32:35], s52 offen lds
    buffer_load_dwordx4 v9, s[32:35], s52 offen offset:1024 lds
    s_add_u32 s52, s52, s53
    v_mov_b32 v92, 0
    v_mov_b32 v93, 0
    v_mov_b32 v94, 0
    v_mov_b32 v95, 0
    v_mov_b32 v96, 0
    v_mov_b32 v97, 0
    v_mov_b32 v98, 0
    v_mov_b32 v99, 0
    v_mov_b32 v100, 0
    v_mov_b32 v101, 0
    v_mov_b32 v102, 0
    v_mov_b32 v103, 0
    v_mov_b32 v104, 0
    v_mov_b32 v105, 0
    v_mov_b32 v106, 0
    v_mov_b32 v107, 0
    v_mov_b32 v108, 0
    v_mov_b32 v109, 0
    v_mov_b32 v110, 0
    v_mov_b32 v111, 0
    v_mov_b32 v128, 0
    v_mov_b32 v129, 0
    v_mov_b32 v130, 0
    v_mov_b32 v131, 0
    v_mov_b32 v132, 0
    v_mov_b32 v133, 0
    v_mov_b32 v134, 0
    v_mov_b32 v135, 0
    v_mov_b32 v136, 0
    v_mov_b32 v137, 0
    v_mov_b32 v138, 0
    v_mov_b32 v139, 0
    v_mov_b32 v140, 0
    v_mov_b32 v141, 0
    v_mov_b32 v142, 0
    v_mov_b32 v143, 0
    s_barrier
    s_mov_b32 s56, 2
L_ploop:
    v_mfma_f32_16x16x32_bf16 v[176:179], v[128:131], v[92:95], v[176:179]
    ds_read_b32 v23, v10 offset:4
    ds_read_b128 v[72:75], v6 offset:0
    v_mfma_f32_16x16x32_bf16 v[180:183], v[128:131], v[96:99], v[180:183]
    ds_read_b128 v[76:79], v6 offset:2048
    v_mfma_f32_16x16x32_bf16 v[184:187], v[128:131], v[100:103], v[184:187]
    ds_read_b128 v[80:83], v6 offset:4096
    ds_read_b128 v[84:87], v6 offset:6144
    v_mfma_f32_16x16x32_bf16 v[188:191], v[128:131], v[104:107], v[188:191]
    ds_read_b128 v[88:91], v6 offset:8192
    v_mfma_f32_16x16x32_bf16 v[192:195], v[128:131], v[108:111], v[192:195]
    s_waitcnt vmcnt(8)
    ds_read_b64_tr_b16 v[112:113], v2 offset:0
    v_mfma_f32_16x16x32_bf16 v[196:199], v[132:135], v[92:95], v[196:199]
    ds_read_b64_tr_b16 v[114:115], v2 offset:512
    s_add_u32 m0, s55, 36864
    v_mfma_f32_16x16x32_bf16 v[200:203], v[132:135], v[96:99], v[200:203]
    ds_read_b64_tr_b16 v[116:117], v3 offset:0
    ds_read_b64_tr_b16 v[118:119], v3 offset:512
    s_waitcnt lgkmcnt(9)
    v_cmp_eq_u32 vcc, s56, v23
    s_nop 0
    s_cbranch_vccnz L_psync_even
L_psyncj_even:
    buffer_load_dwordx4 v8, s[32:35], s52 offen lds
    v_mfma_f32_16x16x32_bf16 v[204:207], v[132:135], v[100:103], v[204:207]
    ds_read_b64_tr_b16 v[120:121], v4 offset:0
    v_mfma_f32_16x16x32_bf16 v[208:211], v[132:135], v[104:107], v[208:211]
    ds_read_b64_tr_b16 v[122:123], v4 offset:512
    ds_read_b64_tr_b16 v[124:125], v5 offset:0
    v_mfma_f32_16x16x32_bf16 v[212:215], v[132:135], v[108:111], v[212:215]
    ds_read_b64_tr_b16 v[126:127], v5 offset:512
    v_mfma_f32_16x16x32_bf16 v[216:219], v[136:139], v[92:95], v[216:219]
    buffer_load_dwordx4 v9, s[32:35], s52 offen offset:1024 lds
    s_add_u32 s52, s52, s53
    v_mfma_f32_16x16x32_bf16 v[220:223], v[136:139], v[96:99], v[220:223]
    v_mfma_f32_16x16x32_bf16 v[224:227], v[136:139], v[100:103], v[224:227]
    v_mfma_f32_16x16x32_bf16 v[228:231], v[136:139], v[104:107], v[228:231]
    s_add_u32 m0, s55, 38912
    v_mfma_f32_16x16x32_bf16 v[232:235], v[136:139], v[108:111], v[232:235]
    buffer_load_dwordx4 v8, s[32:35], s52 offen lds
    v_mfma_f32_16x16x32_bf16 v[236:239], v[140:143], v[92:95], v[236:239]
    v_mfma_f32_16x16x32_bf16 v[240:243], v[140:143], v[96:99], v[240:243]
    v_mfma_f32_16x16x32_bf16 v[244:247], v[140:143], v[100:103], v[244:247]
    v_mfma_f32_16x16x32_bf16 v[248:251], v[140:143], v[104:107], v[248:251]
    buffer_load_dwordx4 v9, s[32:35], s52 offen offset:1024 lds
    s_and_b32 s52, s90, 15
    s_lshr_b64 s[90:91], s[90:91], 4
    s_mul_i32 s52, s52, s54
    s_add_u32 s52, s52, s57
    v_mfma_f32_16x16x32_bf16 v[252:255], v[140:143], v[108:111], v[252:255]
    s_cmp_lg_u32 s80, 0
    s_cbranch_scc1 L_prare_even
L_pjoin_even:
    s_mov_b32 s80, s81
    s_cmp_eq_u32 s56, 10
    s_cbranch_scc1 L_ppf
L_ppfj:
    s_waitcnt lgkmcnt(0)
    v_mfma_f32_16x16x32_bf16 v[176:179], v[112:115], v[72:75], v[176:179]
    ds_read_b128 v[92:95], v7 offset:0
    ds_read_b128 v[96:99], v7 offset:2048
    v_mfma_f32_16x16x32_bf16 v[180:183], v[112:115], v[76:79], v[180:183]
    ds_read_b128 v[100:103], v7 offset:4096
    v_mfma_f32_16x16x32_bf16 v[184:187], v[112:115], v[80:83], v[184:187]
    ds_read_b128 v[104:107], v7 offset:6144
    ds_read_b128 v[108:111], v7 offset:8192
    v_mfma_f32_16x16x32_bf16 v[188:191], v[112:115], v[84:87], v[188:191]
    s_waitcnt vmcnt(8)
    v_mfma_f32_16x16x32_bf16 v[192:195], v[112:115], v[88:91], v[192:195]
    ds_read_b64_tr_b16 v[128:129], v2 offset:4096
    v_mfma_f32_16x16x32_bf16 v[196:199], v[116:119], v[72:75], v[196:199]
    ds_read_b64_tr_b16 v[130:131], v2 offset:4608
    ds_read_b64_tr_b16 v[132:133], v3 offset:4096
    s_add_u32 m0, s55, 0
    v_mfma_f32_16x16x32_bf16 v[200:203], v[116:119], v[76:79], v[200:203]
    ds_read_b64_tr_b16 v[134:135], v3 offset:4608
    buffer_load_dwordx4 v8, s[32:35], s52 offen lds
    v_mfma_f32_16x16x32_bf16 v[204:207], v[116:119], v[80:83], v[204:207]
    ds_read_b64_tr_b16 v[136:137], v4 offset:4096
    ds_read_b64_tr_b16 v[138:139], v4 offset:4608
    v_mfma_f32_16x16x32_bf16 v[208:211], v[116:119], v[84:87], v[208:211]
    ds_read_b64_tr_b16 v[140:141], v5 offset:4096
    v_mfma_f32_16x16x32_bf16 v[212:215], v[116:119], v[88:91], v[212:215]
    ds_read_b64_tr_b16 v[142:143], v5 offset:4608
    v_mfma_f32_16x16x32_bf16 v[216:219], v[120:123], v[72:75], v[216:219]
    buffer_load_dwordx4 v9, s[32:35], s52 offen offset:1024 lds
    s_add_u32 s52, s52, s53
    v_mfma_f32_16x16x32_bf16 v[220:223], v[120:123], v[76:79], v[220:223]
    v_mfma_f32_16x16x32_bf16 v[224:227], v[120:123], v[80:83], v[224:227]
    v_mfma_f32_16x16x32_bf16 v[228:231], v[120:123], v[84:87], v[228:231]
    s_add_u32 m0, s55, 2048
    v_mfma_f32_16x16x32_bf16 v[232:235], v[120:123], v[88:91], v[232:235]
    buffer_load_dwordx4 v8, s[32:35], s52 offen lds
    s_add_u32 s56, s56, 1
    s_mov_b32 s81, 0
    v_mfma_f32_16x16x32_bf16 v[236:239], v[124:127], v[72:75], v[236:239]
    v_mfma_f32_16x16x32_bf16 v[240:243], v[124:127], v[76:79], v[240:243]
    v_mfma_f32_16x16x32_bf16 v[244:247], v[124:127], v[80:83], v[244:247]
    v_mfma_f32_16x16x32_bf16 v[248:251], v[124:127], v[84:87], v[248:251]
    buffer_load_dwordx4 v9, s[32:35], s52 offen offset:1024 lds
    s_add_u32 s52, s52, s53
    v_mfma_f32_16x16x32_bf16 v[252:255], v[124:127], v[88:91], v[252:255]
    s_waitcnt lgkmcnt(0)
    s_barrier
    v_mfma_f32_16x16x32_bf16 v[176:179], v[128:131], v[92:95], v[176:179]
    ds_read_b32 v23, v10 offset:0
    ds_read_b128 v[72:75], v6 offset:10240
    v_mfma_f32_16x16x32_bf16 v[180:183], v[128:131], v[96:99], v[180:183]
    ds_read_b128 v[76:79], v6 offset:12288
    v_mfma_f32_16x16x32_bf16 v[184:187], v[128:131], v[100:103], v[184:187]
    ds_read_b128 v[80:83], v6 offset:14336
    ds_read_b128 v[84:87], v6 offset:16384
    v_mfma_f32_16x16x32_bf16 v[188:191], v[128:131], v[104:107], v[188:191]
    ds_read_b128 v[88:91], v6 offset:18432
    v_mfma_f32_16x16x32_bf16 v[192:195], v[128:131], v[108:111], v[192:195]
    s_waitcnt vmcnt(8)
    ds_read_b64_tr_b16 v[112:113], v2 offset:32768
    v_mfma_f32_16x16x32_bf16 v[196:199], v[132:135], v[92:95], v[196:199]
    ds_read_b64_tr_b16 v[114:115], v2 offset:33280
    s_add_u32 m0, s55, 4096
    v_mfma_f32_16x16x32_bf16 v[200:203], v[132:135], v[96:99], v[200:203]
    ds_read_b64_tr_b16 v[116:117], v3 offset:32768
    ds_read_b64_tr_b16 v[118:119], v3 offset:33280
    s_waitcnt lgkmcnt(9)
    v_cmp_eq_u32 vcc, s56, v23
    s_nop 0
    s_cbranch_vccnz L_psync_odd
L_psyncj_odd:
    buffer_load_dwordx4 v8, s[32:35], s52 offen lds
    v_mfma_f32_16x16x32_bf16 v[204:207], v[132:135], v[100:103], v[204:207]
    ds_read_b64_tr_b16 v[120:121], v4 offset:32768
    v_mfma_f32_16x16x32_bf16 v[208:211], v[132:135], v[104:107], v[208:211]
    ds_read_b64_tr_b16 v[122:123], v4 offset:33280
    ds_read_b64_tr_b16 v[124:125], v5 offset:32768
    v_mfma_f32_16x16x32_bf16 v[212:215], v[132:135], v[108:111], v[212:215]
    ds_read_b64_tr_b16 v[126:127], v5 offset:33280
    v_mfma_f32_16x16x32_bf16 v[216:219], v[136:139], v[92:95], v[216:219]
    buffer_load_dwordx4 v9, s[32:35], s52 offen offset:1024 lds
    s_add_u32 s52, s52, s53
    v_mfma_f32_16x16x32_bf16 v[220:223], v[136:139], v[96:99], v[220:223]
    v_mfma_f32_16x16x32_bf16 v[224:227], v[136:139], v[100:103], v[224:227]
    v_mfma_f32_16x16x32_bf16 v[228:231], v[136:139], v[104:107], v[228:231]
    s_add_u32 m0, s55, 6144
    v_mfma_f32_16x16x32_bf16 v[232:235], v[136:139], v[108:111], v[232:235]
    buffer_load_dwordx4 v8, s[32:35], s52 offen lds
    v_mfma_f32_16x16x32_bf16 v[236:239], v[140:143], v[92:95], v[236:239]
    v_mfma_f32_16x16x32_bf16 v[240:243], v[140:143], v[96:99], v[240:243]
    v_mfma_f32_16x16x32_bf16 v[244:247], v[140:143], v[100:103], v[244:247]
    v_mfma_f32_16x16x32_bf16 v[248:251], v[140:143], v[104:107], v[248:251]
    buffer_load_dwordx4 v9, s[32:35], s52 offen offset:1024 lds
    s_and_b32 s52, s90, 15
    s_lshr_b64 s[90:91], s[90:91], 4
    s_mul_i32 s52, s52, s54
    s_add_u32 s52, s52, s57
    v_mfma_f32_16x16x32_bf16 v[252:255], v[140:143], v[108:111], v[252:255]
    s_cmp_lg_u32 s80, 0
    s_cbranch_scc1 L_prare_odd
L_pjoin_odd:
    s_mov_b32 s80, s81
    s_waitcnt lgkmcnt(0)
    v_mfma_f32_16x16x32_bf16 v[176:179], v[112:115], v[72:75], v[176:179]
    ds_read_b128 v[92:95], v7 offset:10240
    ds_read_b128 v[96:99], v7 offset:12288
    v_mfma_f32_16x16x32_bf16 v[180:183], v[112:115], v[76:79], v[180:183]
    ds_read_b128 v[100:103], v7 offset:14336
    v_mfma_f32_16x16x32_bf16 v[184:187], v[112:115], v[80:83], v[184:187]
    ds_read_b128 v[104:107], v7 offset:16384
    ds_read_b128 v[108:111], v7 offset:18432
    v_mfma_f32_16x16x32_bf16 v[188:191], v[112:115], v[84:87], v[188:191]
    s_waitcnt vmcnt(8)
    v_mfma_f32_16x16x32_bf16 v[192:195], v[112:115], v[88:91], v[192:195]
    ds_read_b64_tr_b16 v[128:129], v2 offset:36864
    v_mfma_f32_16x16x32_bf16 v[196:199], v[116:119], v[72:75], v[196:199]
    ds_read_b64_tr_b16 v[130:131], v2 offset:37376
    ds_read_b64_tr_b16 v[132:133], v3 offset:36864
    s_add_u32 m0, s55, 32768
    v_mfma_f32_16x16x32_bf16 v[200:203], v[116:119], v[76:79], v[200:203]
    ds_read_b64_tr_b16 v[134:135], v3 offset:37376
    buffer_load_dwordx4 v8, s[32:35], s52 offen lds
    v_mfma_f32_16x16x32_bf16 v[204:207], v[116:119], v[80:83], v[204:207]
    ds_read_b64_tr_b16 v[136:137], v4 offset:36864
    ds_read_b64_tr_b16 v[138:139], v4 offset:37376
    v_mfma_f32_16x16x32_bf16 v[208:211], v[116:119], v[84:87], v[208:211]
    ds_read_b64_tr_b16 v[140:141], v5 offset:36864
    v_mfma_f32_16x16x32_bf16 v[212:215], v[116:119], v[88:91], v[212:215]
    ds_read_b64_tr_b16 v[142:143], v5 offset:37376
    v_mfma_f32_16x16x32_bf16 v[216:219], v[120:123], v[72:75], v[216:219]
    buffer_load_dwordx4 v9, s[32:35], s52 offen offset:1024 lds
    s_add_u32 s52, s52, s53
    v_mfma_f32_16x16x32_bf16 v[220:223], v[120:123], v[76:79], v[220:223]
    v_mfma_f32_16x16x32_bf16 v[224:227], v[120:123], v[80:83], v[224:227]
    v_mfma_f32_16x16x32_bf16 v[228:231], v[120:123], v[84:87], v[228:231]
    s_add_u32 m0, s55, 34816
    v_mfma_f32_16x16x32_bf16 v[232:235], v[120:123], v[88:91], v[232:235]
    buffer_load_dwordx4 v8, s[32:35], s52 offen lds
    s_add_u32 s56, s56, 1
    s_mov_b32 s81, 0
    v_mfma_f32_16x16x32_bf16 v[236:239], v[124:127], v[72:75], v[236:239]
    v_mfma_f32_16x16x32_bf16 v[240:243], v[124:127], v[76:79], v[240:243]
    v_mfma_f32_16x16x32_bf16 v[244:247], v[124:127], v[80:83], v[244:247]
    v_mfma_f32_16x16x32_bf16 v[248:251], v[124:127], v[84:87], v[248:251]
    buffer_load_dwordx4 v9, s[32:35], s52 offen offset:1024 lds
    s_add_u32 s52, s52, s53
    v_mfma_f32_16x16x32_bf16 v[252:255], v[124:127], v[88:91], v[252:255]
    s_waitcnt lgkmcnt(0)
    s_barrier
    s_cmp_lt_u32 s56, 16
    s_cbranch_scc1 L_ploop
    v_mfma_f32_16x16x32_bf16 v[176:179], v[128:131], v[92:95], v[176:179]
    ds_read_b32 v23, v10 offset:4
    ds_read_b128 v[72:75], v6 offset:0
    v_mfma_f32_16x16x32_bf16 v[180:183], v[128:131], v[96:99], v[180:183]
    ds_read_b128 v[76:79], v6 offset:2048
    v_mfma_f32_16x16x32_bf16 v[184:187], v[128:131], v[100:103], v[184:187]
    ds_read_b128 v[80:83], v6 offset:4096
    ds_read_b128 v[84:87], v6 offset:6144
    v_mfma_f32_16x16x32_bf16 v[188:191], v[128:131], v[104:107], v[188:191]
    ds_read_b128 v[88:91], v6 offset:8192
    v_mfma_f32_16x16x32_bf16 v[192:195], v[128:131], v[108:111], v[192:195]
    s_waitcnt vmcnt(8)
    ds_read_b64_tr_b16 v[112:113], v2 offset:0
    v_mfma_f32_16x16x32_bf16 v[196:199], v[132:135], v[92:95], v[196:199]
    ds_read_b64_tr_b16 v[114:115], v2 offset:512
    s_add_u32 m0, s55, 36864
    v_mfma_f32_16x16x32_bf16 v[200:203], v[132:135], v[96:99], v[200:203]
    ds_read_b64_tr_b16 v[116:117], v3 offset:0
    ds_read_b64_tr_b16 v[118:119], v3 offset:512
    s_waitcnt lgkmcnt(9)
    v_cmp_eq_u32 vcc, s56, v23
    s_nop 0
    s_cbranch_vccnz L_psync_d14
L_psyncj_d14:
    buffer_load_dwordx4 v8, s[32:35], s52 offen lds
    v_mfma_f32_16x16x32_bf16 v[204:207], v[132:135], v[100:103], v[204:207]
    ds_read_b64_tr_b16 v[120:121], v4 offset:0
    v_mfma_f32_16x16x32_bf16 v[208:211], v[132:135], v[104:107], v[208:211]
    ds_read_b64_tr_b16 v[122:123], v4 offset:512
    ds_read_b64_tr_b16 v[124:125], v5 offset:0
    v_mfma_f32_16x16x32_bf16 v[212:215], v[132:135], v[108:111], v[212:215]
    ds_read_b64_tr_b16 v[126:127], v5 offset:512
    v_mfma_f32_16x16x32_bf16 v[216:219], v[136:139], v[92:95], v[216:219]
    buffer_load_dwordx4 v9, s[32:35], s52 offen offset:1024 lds
    s_add_u32 s52, s52, s53
    v_mfma_f32_16x16x32_bf16 v[220:223], v[136:139], v[96:99], v[220:223]
    v_mfma_f32_16x16x32_bf16 v[224:227], v[136:139], v[100:103], v[224:227]
    v_mfma_f32_16x16x32_bf16 v[228:231], v[136:139], v[104:107], v[228:231]
    s_add_u32 m0, s55, 38912
    v_mfma_f32_16x16x32_bf16 v[232:235], v[136:139], v[108:111], v[232:235]
    buffer_load_dwordx4 v8, s[32:35], s52 offen lds
    v_mfma_f32_16x16x32_bf16 v[236:239], v[140:143], v[92:95], v[236:239]
    v_mfma_f32_16x16x32_bf16 v[240:243], v[140:143], v[96:99], v[240:243]
    v_mfma_f32_16x16x32_bf16 v[244:247], v[140:143], v[100:103], v[244:247]
    v_mfma_f32_16x16x32_bf16 v[248:251], v[140:143], v[104:107], v[248:251]
    buffer_load_dwordx4 v9, s[32:35], s52 offen offset:1024 lds
    s_and_b32 s52, s90, 15
    s_lshr_b64 s[90:91], s[90:91], 4
    s_mul_i32 s52, s52, s54
    s_add_u32 s52, s52, s57
    v_mfma_f32_16x16x32_bf16 v[252:255], v[140:143], v[108:111], v[252:255]
    s_cmp_lg_u32 s80, 0
    s_cbranch_scc1 L_prare_d14
L_pjoin_d14:
    s_mov_b32 s80, s81
    s_mov_b32 s32, s44
    s_mov_b32 s33, s45
    s_mov_b32 s34, s46
    s_lshl_b32 s52, s58, 7
    s_mov_b32 s57, s52
    s_mov_b32 s53, 14336
    s_mov_b32 s54, 57344
    s_mov_b32 s90, 0x4321
    v_lshrrev_b32 v17, 3, v1
    v_and_b32 v17, 2, v17
    v_and_b32 v18, 7, v1
    v_xor_b32 v17, v17, v18
    v_lshlrev_b32 v17, 4, v17
    v_lshrrev_b32 v18, 3, v1
    v_mul_u32_u24 v18, 896, v18
    v_add_u32 v8, v17, v18
    v_xor_b32 v17, 64, v17
    v_add_u32 v9, v17, v18
    v_add_u32 v9, 6144, v9
    s_cmp_eq_u32 s20, 7
    s_cselect_b32 s34, 0, s34
    s_cselect_b32 s55, 0x30000, s55
    s_waitcnt lgkmcnt(0)
    v_mfma_f32_16x16x32_bf16 v[176:179], v[112:115], v[72:75], v[176:179]
    ds_read_b128 v[92:95], v7 offset:0
    ds_read_b128 v[96:99], v7 offset:2048
    v_mfma_f32_16x16x32_bf16 v[180:183], v[112:115], v[76:79], v[180:183]
    ds_read_b128 v[100:103], v7 offset:4096
    v_mfma_f32_16x16x32_bf16 v[184:187], v[112:115], v[80:83], v[184:187]
    ds_read_b128 v[104:107], v7 offset:6144
    ds_read_b128 v[108:111], v7 offset:8192
    v_mfma_f32_16x16x32_bf16 v[188:191], v[112:115], v[84:87], v[188:191]
    s_waitcnt vmcnt(8)
    v_mfma_f32_16x16x32_bf16 v[192:195], v[112:115], v[88:91], v[192:195]
    ds_read_b64_tr_b16 v[128:129], v2 offset:4096
    v_mfma_f32_16x16x32_bf16 v[196:199], v[116:119], v[72:75], v[196:199]
    ds_read_b64_tr_b16 v[130:131], v2 offset:4608
    ds_read_b64_tr_b16 v[132:133], v3 offset:4096
    s_add_u32 m0, s55, 0
    v_mfma_f32_16x16x32_bf16 v[200:203], v[116:119], v[76:79], v[200:203]
    ds_read_b64_tr_b16 v[134:135], v3 offset:4608
    buffer_load_dwordx4 v8, s[32:35], s52 offen lds
    v_mfma_f32_16x16x32_bf16 v[204:207], v[116:119], v[80:83], v[204:207]
    ds_read_b64_tr_b16 v[136:137], v4 offset:4096
    ds_read_b64_tr_b16 v[138:139], v4 offset:4608
    v_mfma_f32_16x16x32_bf16 v[208:211], v[116:119], v[84:87], v[208:211]
    ds_read_b64_tr_b16 v[140:141], v5 offset:4096
    v_mfma_f32_16x16x32_bf16 v[212:215], v[116:119], v[88:91], v[212:215]
    ds_read_b64_tr_b16 v[142:143], v5 offset:4608
    v_mfma_f32_16x16x32_bf16 v[216:219], v[120:123], v[72:75], v[216:219]
    buffer_load_dwordx4 v9, s[32:35], s52 offen offset:1024 lds
    s_add_u32 s52, s52, s53
    v_mfma_f32_16x16x32_bf16 v[220:223], v[120:123], v[76:79], v[220:223]
    v_mfma_f32_16x16x32_bf16 v[224:227], v[120:123], v[80:83], v[224:227]
    v_mfma_f32_16x16x32_bf16 v[228:231], v[120:123], v[84:87], v[228:231]
    s_add_u32 m0, s55, 2048
    v_mfma_f32_16x16x32_bf16 v[232:235], v[120:123], v[88:91], v[232:235]
    buffer_load_dwordx4 v8, s[32:35], s52 offen lds
    s_add_u32 s56, s56, 1
    s_mov_b32 s81, 0
    v_mfma_f32_16x16x32_bf16 v[236:239], v[124:127], v[72:75], v[236:239]
    v_mfma_f32_16x16x32_bf16 v[240:243], v[124:127], v[76:79], v[240:243]
    v_mfma_f32_16x16x32_bf16 v[244:247], v[124:127], v[80:83], v[244:247]
    v_mfma_f32_16x16x32_bf16 v[248:251], v[124:127], v[84:87], v[248:251]
    buffer_load_dwordx4 v9, s[32:35], s52 offen offset:1024 lds
    s_add_u32 s52, s52, s53
    v_mfma_f32_16x16x32_bf16 v[252:255], v[124:127], v[88:91], v[252:255]
    s_waitcnt lgkmcnt(0)
    v_mfma_f32_16x16x32_bf16 v[176:179], v[128:131], v[92:95], v[176:179]
    s_waitcnt vmcnt(8)
    v_mfma_f32_16x16x32_bf16 v[180:183], v[128:131], v[96:99], v[180:183]
    ds_read_b64_tr_b16 v[112:113], v2 offset:32768
    v_mfma_f32_16x16x32_bf16 v[184:187], v[128:131], v[100:103], v[184:187]
    ds_read_b64_tr_b16 v[114:115], v2 offset:33280
    v_mfma_f32_16x16x32_bf16 v[188:191], v[128:131], v[104:107], v[188:191]
    ds_read_b64_tr_b16 v[116:117], v3 offset:32768
    v_mfma_f32_16x16x32_bf16 v[192:195], v[128:131], v[108:111], v[192:195]
    ds_read_b64_tr_b16 v[118:119], v3 offset:33280
    v_mfma_f32_16x16x32_bf16 v[196:199], v[132:135], v[92:95], v[196:199]
    ds_read_b64_tr_b16 v[120:121], v4 offset:32768
    v_mfma_f32_16x16x32_bf16 v[200:203], v[132:135], v[96:99], v[200:203]
    ds_read_b64_tr_b16 v[122:123], v4 offset:33280
    v_mfma_f32_16x16x32_bf16 v[204:207], v[132:135], v[100:103], v[204:207]
    ds_read_b64_tr_b16 v[124:125], v5 offset:32768
    v_mfma_f32_16x16x32_bf16 v[208:211], v[132:135], v[104:107], v[208:211]
    ds_read_b64_tr_b16 v[126:127], v5 offset:33280
    v_mfma_f32_16x16x32_bf16 v[212:215], v[132:135], v[108:111], v[212:215]
    s_add_u32 m0, s55, 4096
    v_mfma_f32_16x16x32_bf16 v[216:219], v[136:139], v[92:95], v[216:219]
    buffer_load_dwordx4 v8, s[32:35], s52 offen lds
    v_mfma_f32_16x16x32_bf16 v[220:223], v[136:139], v[96:99], v[220:223]
    v_mfma_f32_16x16x32_bf16 v[224:227], v[136:139], v[100:103], v[224:227]
    buffer_load_dwordx4 v9, s[32:35], s52 offen offset:1024 lds
    s_add_u32 s52, s52, s53
    v_mfma_f32_16x16x32_bf16 v[228:231], v[136:139], v[104:107], v[228:231]
    s_add_u32 m0, s55, 6144
    v_mfma_f32_16x16x32_bf16 v[232:235], v[136:139], v[108:111], v[232:235]
    buffer_load_dwordx4 v8, s[32:35], s52 offen lds
    v_mfma_f32_16x16x32_bf16 v[236:239], v[140:143], v[92:95], v[236:239]
    v_mfma_f32_16x16x32_bf16 v[240:243], v[140:143], v[96:99], v[240:243]
    buffer_load_dwordx4 v9, s[32:35], s52 offen offset:1024 lds
    s_and_b32 s52, s90, 15
    s_lshr_b64 s[90:91], s[90:91], 4
    s_mul_i32 s52, s52, s54
    s_add_u32 s52, s52, s57
    v_mfma_f32_16x16x32_bf16 v[244:247], v[140:143], v[100:103], v[244:247]
    v_mfma_f32_16x16x32_bf16 v[248:251], v[140:143], v[104:107], v[248:251]
    v_mfma_f32_16x16x32_bf16 v[252:255], v[140:143], v[108:111], v[252:255]
    s_barrier
    ds_read_b128 v[72:75], v6 offset:10240
    ds_read_b128 v[76:79], v6 offset:12288
    ds_read_b128 v[80:83], v6 offset:14336
    ds_read_b128 v[84:87], v6 offset:16384
    ds_read_b128 v[88:91], v6 offset:18432
    s_cmp_lg_u32 s80, 0
    s_cbranch_scc1 L_prare_d15
L_pjoin_d15:
    ds_read_b128 v[92:95], v7 offset:10240
    ds_read_b128 v[96:99], v7 offset:12288
    s_waitcnt lgkmcnt(6)
    v_mfma_f32_16x16x32_bf16 v[176:179], v[112:115], v[72:75], v[176:179]
    ds_read_b128 v[100:103], v7 offset:14336
    s_waitcnt lgkmcnt(6)
    v_mfma_f32_16x16x32_bf16 v[180:183], v[112:115], v[76:79], v[180:183]
    ds_read_b128 v[104:107], v7 offset:16384
    ds_read_b128 v[108:111], v7 offset:18432
    s_waitcnt lgkmcnt(7)
    v_mfma_f32_16x16x32_bf16 v[184:187], v[112:115], v[80:83], v[184:187]
    s_waitcnt vmcnt(8)
    s_waitcnt lgkmcnt(6)
    v_mfma_f32_16x16x32_bf16 v[188:191], v[112:115], v[84:87], v[188:191]
    ds_read_b64_tr_b16 v[128:129], v2 offset:36864
    s_waitcnt lgkmcnt(6)
    v_mfma_f32_16x16x32_bf16 v[192:195], v[112:115], v[88:91], v[192:195]
    ds_read_b64_tr_b16 v[130:131], v2 offset:37376
    ds_read_b64_tr_b16 v[132:133], v3 offset:36864
    v_mfma_f32_16x16x32_bf16 v[196:199], v[116:119], v[72:75], v[196:199]
    ds_read_b64_tr_b16 v[134:135], v3 offset:37376
    v_mfma_f32_16x16x32_bf16 v[200:203], v[116:119], v[76:79], v[200:203]
    ds_read_b64_tr_b16 v[136:137], v4 offset:36864
    ds_read_b64_tr_b16 v[138:139], v4 offset:37376
    v_mfma_f32_16x16x32_bf16 v[204:207], v[116:119], v[80:83], v[204:207]
    ds_read_b64_tr_b16 v[140:141], v5 offset:36864
    v_mfma_f32_16x16x32_bf16 v[208:211], v[116:119], v[84:87], v[208:211]
    ds_read_b64_tr_b16 v[142:143], v5 offset:37376
    v_mfma_f32_16x16x32_bf16 v[212:215], v[116:119], v[88:91], v[212:215]
    v_mfma_f32_16x16x32_bf16 v[216:219], v[120:123], v[72:75], v[216:219]
    v_mfma_f32_16x16x32_bf16 v[220:223], v[120:123], v[76:79], v[220:223]
    v_mfma_f32_16x16x32_bf16 v[224:227], v[120:123], v[80:83], v[224:227]
    v_add_u32 v22, 90112, v21
    v_xor_b32 v23, 64, v22
    v_mfma_f32_16x16x32_bf16 v[228:231], v[120:123], v[84:87], v[228:231]
    v_mfma_f32_16x16x32_bf16 v[232:235], v[120:123], v[88:91], v[232:235]
    v_mfma_f32_16x16x32_bf16 v[236:239], v[124:127], v[72:75], v[236:239]
    v_mfma_f32_16x16x32_bf16 v[240:243], v[124:127], v[76:79], v[240:243]
    v_mfma_f32_16x16x32_bf16 v[244:247], v[124:127], v[80:83], v[244:247]
    v_mfma_f32_16x16x32_bf16 v[248:251], v[124:127], v[84:87], v[248:251]
    v_mfma_f32_16x16x32_bf16 v[252:255], v[124:127], v[88:91], v[252:255]
    s_waitcnt lgkmcnt(0)
    s_barrier
    v_mfma_f32_16x16x32_bf16 v[176:179], v[128:131], v[92:95], v[176:179]
    v_mfma_f32_16x16x32_bf16 v[196:199], v[132:135], v[92:95], v[196:199]
    v_mfma_f32_16x16x32_bf16 v[180:183], v[128:131], v[96:99], v[180:183]
    v_mfma_f32_16x16x32_bf16 v[200:203], v[132:135], v[96:99], v[200:203]
    v_mfma_f32_16x16x32_bf16 v[184:187], v[128:131], v[100:103], v[184:187]
    s_nop 3
    v_cvt_pk_bf16_f32 v176, v176, v177
    v_cvt_pk_bf16_f32 v177, v178, v179
    v_cvt_pk_bf16_f32 v178, v196, v197
    v_cvt_pk_bf16_f32 v179, v198, v199
    s_nop 0
    v_permlane16_swap_b32 v176, v178
    v_permlane16_swap_b32 v177, v179
    ds_write_b128 v22, v[176:179] offset:40960
    v_mfma_f32_16x16x32_bf16 v[204:207], v[132:135], v[100:103], v[204:207]
    v_mfma_f32_16x16x32_bf16 v[188:191], v[128:131], v[104:107], v[188:191]
    v_cvt_pk_bf16_f32 v180, v180, v181
    v_cvt_pk_bf16_f32 v181, v182, v183
    v_cvt_pk_bf16_f32 v182, v200, v201
    v_cvt_pk_bf16_f32 v183, v202, v203
    s_nop 0
    v_permlane16_swap_b32 v180, v182
    v_permlane16_swap_b32 v181, v183
    ds_write_b128 v22, v[180:183] offset:49152
    v_mfma_f32_16x16x32_bf16 v[208:211], v[132:135], v[104:107], v[208:211]
    v_mfma_f32_16x16x32_bf16 v[192:195], v[128:131], v[108:111], v[192:195]
    v_cvt_pk_bf16_f32 v184, v184, v185
    v_cvt_pk_bf16_f32 v185, v186, v187
    v_cvt_pk_bf16_f32 v186, v204, v205
    v_cvt_pk_bf16_f32 v187, v206, v207
    s_nop 0
    v_permlane16_swap_b32 v184, v186
    v_permlane16_swap_b32 v185, v187
    ds_write_b128 v22, v[184:187] offset:57344
    v_mfma_f32_16x16x32_bf16 v[212:215], v[132:135], v[108:111], v[212:215]
    v_mfma_f32_16x16x32_bf16 v[216:219], v[136:139], v[92:95], v[216:219]
    v_cvt_pk_bf16_f32 v188, v188, v189
    v_cvt_pk_bf16_f32 v189, v190, v191
    v_cvt_pk_bf16_f32 v190, v208, v209
    v_cvt_pk_bf16_f32 v191, v210, v211
    s_nop 0
    v_permlane16_swap_b32 v188, v190
    v_permlane16_swap_b32 v189, v191
    ds_write_b128 v22, v[188:191] offset:0
    v_mfma_f32_16x16x32_bf16 v[236:239], v[140:143], v[92:95], v[236:239]
    v_mfma_f32_16x16x32_bf16 v[220:223], v[136:139], v[96:99], v[220:223]
    v_cvt_pk_bf16_f32 v192, v192, v193
    v_cvt_pk_bf16_f32 v193, v194, v195
    v_cvt_pk_bf16_f32 v194, v212, v213
    v_cvt_pk_bf16_f32 v195, v214, v215
    s_nop 0
    v_permlane16_swap_b32 v192, v194
    v_permlane16_swap_b32 v193, v195
    ds_write_b128 v22, v[192:195] offset:32768
    v_mfma_f32_16x16x32_bf16 v[240:243], v[140:143], v[96:99], v[240:243]
    v_mfma_f32_16x16x32_bf16 v[224:227], v[136:139], v[100:103], v[224:227]
    v_cvt_pk_bf16_f32 v216, v216, v217
    v_cvt_pk_bf16_f32 v217, v218, v219
    v_cvt_pk_bf16_f32 v218, v236, v237
    v_cvt_pk_bf16_f32 v219, v238, v239
    s_nop 0
    v_permlane16_swap_b32 v216, v218
    v_permlane16_swap_b32 v217, v219
    ds_write_b128 v23, v[216:219] offset:40960
    v_mfma_f32_16x16x32_bf16 v[244:247], v[140:143], v[100:103], v[244:247]
    v_mfma_f32_16x16x32_bf16 v[228:231], v[136:139], v[104:107], v[228:231]
    v_cvt_pk_bf16_f32 v220, v220, v221
    v_cvt_pk_bf16_f32 v221, v222, v223
    v_cvt_pk_bf16_f32 v222, v240, v241
    v_cvt_pk_bf16_f32 v223, v242, v243
    s_nop 0
    v_permlane16_swap_b32 v220, v222
    v_permlane16_swap_b32 v221, v223
    ds_write_b128 v23, v[220:223] offset:49152
    v_mfma_f32_16x16x32_bf16 v[248:251], v[140:143], v[104:107], v[248:251]
    v_mfma_f32_16x16x32_bf16 v[232:235], v[136:139], v[108:111], v[232:235]
    v_cvt_pk_bf16_f32 v224, v224, v225
    v_cvt_pk_bf16_f32 v225, v226, v227
    v_cvt_pk_bf16_f32 v226, v244, v245
    v_cvt_pk_bf16_f32 v227, v246, v247
    s_nop 0
    v_permlane16_swap_b32 v224, v226
    v_permlane16_swap_b32 v225, v227
    ds_write_b128 v23, v[224:227] offset:57344
    v_mfma_f32_16x16x32_bf16 v[252:255], v[140:143], v[108:111], v[252:255]
    v_cvt_pk_bf16_f32 v228, v228, v229
    v_cvt_pk_bf16_f32 v229, v230, v231
    v_cvt_pk_bf16_f32 v230, v248, v249
    v_cvt_pk_bf16_f32 v231, v250, v251
    s_nop 0
    v_permlane16_swap_b32 v228, v230
    v_permlane16_swap_b32 v229, v231
    ds_write_b128 v23, v[228:231] offset:0
    v_cvt_pk_bf16_f32 v232, v232, v233
    v_cvt_pk_bf16_f32 v233, v234, v235
    v_cvt_pk_bf16_f32 v234, v252, v253
    v_cvt_pk_bf16_f32 v235, v254, v255
    s_nop 0
    v_permlane16_swap_b32 v232, v234
    v_permlane16_swap_b32 v233, v235
    ds_write_b128 v23, v[232:235] offset:32768
    s_waitcnt lgkmcnt(0)
    s_barrier
    s_cmp_eq_u32 s20, 7
    s_cbranch_scc1 L_comm
    s_add_u32 m0, s55, 32768
    s_nop 0
    buffer_load_dwordx4 v8, s[32:35], s52 offen lds
    buffer_load_dwordx4 v9, s[32:35], s52 offen offset:1024 lds
    s_add_u32 s52, s52, s53
    s_add_u32 m0, s55, 34816
    s_nop 0
    buffer_load_dwordx4 v8, s[32:35], s52 offen lds
    buffer_load_dwordx4 v9, s[32:35], s52 offen offset:1024 lds
    s_add_u32 s52, s52, s53
    s_add_u32 m0, s55, 36864
    s_nop 0
    buffer_load_dwordx4 v8, s[32:35], s52 offen lds
    buffer_load_dwordx4 v9, s[32:35], s52 offen offset:1024 lds
    s_add_u32 s52, s52, s53
    s_add_u32 m0, s55, 38912
    s_nop 0
    buffer_load_dwordx4 v8, s[32:35], s52 offen lds
    buffer_load_dwordx4 v9, s[32:35], s52 offen offset:1024 lds
    s_and_b32 s52, s90, 15
    s_lshr_b64 s[90:91], s[90:91], 4
    s_mul_i32 s52, s52, s54
    s_add_u32 s52, s52, s57
    s_waitcnt vmcnt(8)
    ds_read_b64_tr_b16 v[128:129], v2 offset:0
    ds_read_b64_tr_b16 v[130:131], v2 offset:512
    ds_read_b64_tr_b16 v[132:133], v3 offset:0
    ds_read_b64_tr_b16 v[134:135], v3 offset:512
    ds_read_b64_tr_b16 v[136:137], v4 offset:0
    ds_read_b64_tr_b16 v[138:139], v4 offset:512
    ds_read_b64_tr_b16 v[140:141], v5 offset:0
    ds_read_b64_tr_b16 v[142:143], v5 offset:512
    ds_read_b64_tr_b16 v[144:145], v2 offset:4096
    ds_read_b64_tr_b16 v[146:147], v2 offset:4608
    ds_read_b64_tr_b16 v[148:149], v3 offset:4096
    ds_read_b64_tr_b16 v[150:151], v3 offset:4608
    ds_read_b64_tr_b16 v[152:153], v4 offset:4096
    ds_read_b64_tr_b16 v[154:155], v4 offset:4608
    ds_read_b64_tr_b16 v[156:157], v5 offset:4096
    s_waitcnt lgkmcnt(14)
    ds_read_b64_tr_b16 v[158:159], v5 offset:4608
    v_add_u32 v6, 90112, v20
    v_xor_b32 v7, 64, v6
    v_and_b32 v18, 15, v1
    v_mul_u32_u24 v18, 144, v18
    v_add_u32 v18, 160256, v18
    s_waitcnt lgkmcnt(14)
    ds_read_b128 v[24:27], v18 offset:0
    s_waitcnt lgkmcnt(14)
    ds_read_b128 v[28:31], v18 offset:16
    s_waitcnt lgkmcnt(14)
    ds_read_b128 v[32:35], v18 offset:32
    s_waitcnt lgkmcnt(14)
    ds_read_b128 v[36:39], v18 offset:48
    s_waitcnt lgkmcnt(14)
    ds_read_b128 v[40:43], v18 offset:64
    s_waitcnt lgkmcnt(4)
    v_add_f32 v24, v24, v25
    v_add_f32 v26, v26, v27
    v_add_f32 v24, v24, v26
    v_rcp_f32 v10, v24
    s_waitcnt lgkmcnt(3)
    v_add_f32 v28, v28, v29
    v_add_f32 v30, v30, v31
    v_add_f32 v28, v28, v30
    v_rcp_f32 v11, v28
    s_waitcnt lgkmcnt(2)
    v_add_f32 v32, v32, v33
    v_add_f32 v34, v34, v35
    v_add_f32 v32, v32, v34
    v_rcp_f32 v12, v32
    s_waitcnt lgkmcnt(1)
    v_add_f32 v36, v36, v37
    v_add_f32 v38, v38, v39
    v_add_f32 v36, v36, v38
    v_rcp_f32 v13, v36
    s_waitcnt lgkmcnt(0)
    v_add_f32 v40, v40, v41
    v_add_f32 v42, v42, v43
    v_add_f32 v40, v40, v42
    v_rcp_f32 v14, v40
    s_waitcnt lgkmcnt(0)
    s_add_u32 m0, s55, 0
    s_nop 0
    buffer_load_dwordx4 v8, s[32:35], s52 offen lds
    buffer_load_dwordx4 v9, s[32:35], s52 offen offset:1024 lds
    s_add_u32 s52, s52, s53
    s_add_u32 m0, s55, 2048
    s_nop 0
    buffer_load_dwordx4 v8, s[32:35], s52 offen lds
    buffer_load_dwordx4 v9, s[32:35], s52 offen offset:1024 lds
    s_add_u32 s52, s52, s53
    s_add_u32 m0, s55, 4096
    s_nop 0
    buffer_load_dwordx4 v8, s[32:35], s52 offen lds
    buffer_load_dwordx4 v9, s[32:35], s52 offen offset:1024 lds
    s_add_u32 s52, s52, s53
    s_add_u32 m0, s55, 6144
    s_nop 0
    buffer_load_dwordx4 v8, s[32:35], s52 offen lds
    buffer_load_dwordx4 v9, s[32:35], s52 offen offset:1024 lds
    s_and_b32 s52, s90, 15
    s_lshr_b64 s[90:91], s[90:91], 4
    s_mul_i32 s52, s52, s54
    s_add_u32 s52, s52, s57
    s_waitcnt vmcnt(8)
    ds_read_b64_tr_b16 v[160:161], v2 offset:32768
    ds_read_b64_tr_b16 v[162:163], v2 offset:33280
    ds_read_b64_tr_b16 v[164:165], v3 offset:32768
    ds_read_b64_tr_b16 v[166:167], v3 offset:33280
    ds_read_b64_tr_b16 v[168:169], v4 offset:32768
    ds_read_b64_tr_b16 v[170:171], v4 offset:33280
    ds_read_b64_tr_b16 v[172:173], v5 offset:32768
    ds_read_b64_tr_b16 v[174:175], v5 offset:33280
    ds_read_b64_tr_b16 v[176:177], v2 offset:36864
    ds_read_b64_tr_b16 v[178:179], v2 offset:37376
    ds_read_b64_tr_b16 v[180:181], v3 offset:36864
    ds_read_b64_tr_b16 v[182:183], v3 offset:37376
    ds_read_b64_tr_b16 v[184:185], v4 offset:36864
    ds_read_b64_tr_b16 v[186:187], v4 offset:37376
    ds_read_b64_tr_b16 v[188:189], v5 offset:36864
    s_waitcnt lgkmcnt(14)
    ds_read_b64_tr_b16 v[190:191], v5 offset:37376
    s_waitcnt lgkmcnt(0)
    s_add_u32 m0, s55, 32768
    s_nop 0
    buffer_load_dwordx4 v8, s[32:35], s52 offen lds
    buffer_load_dwordx4 v9, s[32:35], s52 offen offset:1024 lds
    s_add_u32 s52, s52, s53
    s_add_u32 m0, s55, 34816
    s_nop 0
    buffer_load_dwordx4 v8, s[32:35], s52 offen lds
    buffer_load_dwordx4 v9, s[32:35], s52 offen offset:1024 lds
    s_add_u32 s52, s52, s53
    s_add_u32 m0, s55, 36864
    s_nop 0
    buffer_load_dwordx4 v8, s[32:35], s52 offen lds
    buffer_load_dwordx4 v9, s[32:35], s52 offen offset:1024 lds
    s_add_u32 s52, s52, s53
    s_add_u32 m0, s55, 38912
    s_nop 0
    buffer_load_dwordx4 v8, s[32:35], s52 offen lds
    buffer_load_dwordx4 v9, s[32:35], s52 offen offset:1024 lds
    s_and_b32 s52, s90, 15
    s_lshr_b64 s[90:91], s[90:91], 4
    s_mul_i32 s52, s52, s54
    s_add_u32 s52, s52, s57
    ds_read_b128 v[104:107], v6 offset:40960
    ds_read_b128 v[108:111], v7 offset:40960
    ds_read_b128 v[112:115], v6 offset:43008
    ds_read_b128 v[116:119], v7 offset:43008
    ds_read_b128 v[120:123], v6 offset:49152
    v_lshlrev_b32 v17, 4, v1
    s_mul_i32 s26, s58, 10240
    s_add_u32 s27, s26, 4096
    s_add_u32 s28, s26, 8192
    s_waitcnt lgkmcnt(4)
    v_mfma_f32_16x16x32_bf16 v[24:27], v[128:131], v[104:107], 0
    ds_read_b128 v[124:127], v7 offset:49152
    v_mfma_f32_16x16x32_bf16 v[28:31], v[132:135], v[104:107], 0
    v_mfma_f32_16x16x32_bf16 v[32:35], v[136:139], v[104:107], 0
    v_mfma_f32_16x16x32_bf16 v[36:39], v[140:143], v[104:107], 0
    s_waitcnt lgkmcnt(4)
    v_mfma_f32_16x16x32_bf16 v[24:27], v[144:147], v[108:111], v[24:27]
    ds_read_b128 v[104:107], v6 offset:51200
    v_mfma_f32_16x16x32_bf16 v[28:31], v[148:151], v[108:111], v[28:31]
    v_mfma_f32_16x16x32_bf16 v[32:35], v[152:155], v[108:111], v[32:35]
    v_mfma_f32_16x16x32_bf16 v[36:39], v[156:159], v[108:111], v[36:39]
    s_waitcnt lgkmcnt(4)
    v_mfma_f32_16x16x32_bf16 v[24:27], v[160:163], v[112:115], v[24:27]
    ds_read_b128 v[108:111], v7 offset:51200
    v_mfma_f32_16x16x32_bf16 v[28:31], v[164:167], v[112:115], v[28:31]
    v_mfma_f32_16x16x32_bf16 v[32:35], v[168:171], v[112:115], v[32:35]
    v_mfma_f32_16x16x32_bf16 v[36:39], v[172:175], v[112:115], v[36:39]
    s_waitcnt lgkmcnt(4)
    v_mfma_f32_16x16x32_bf16 v[24:27], v[176:179], v[116:119], v[24:27]
    ds_read_b128 v[112:115], v6 offset:57344
    v_mfma_f32_16x16x32_bf16 v[28:31], v[180:183], v[116:119], v[28:31]
    v_mfma_f32_16x16x32_bf16 v[32:35], v[184:187], v[116:119], v[32:35]
    v_mfma_f32_16x16x32_bf16 v[36:39], v[188:191], v[116:119], v[36:39]
    s_waitcnt lgkmcnt(4)
    v_mfma_f32_16x16x32_bf16 v[40:43], v[128:131], v[120:123], 0
    ds_read_b128 v[116:119], v7 offset:57344
    v_mfma_f32_16x16x32_bf16 v[44:47], v[132:135], v[120:123], 0
    v_mfma_f32_16x16x32_bf16 v[48:51], v[136:139], v[120:123], 0
    v_mfma_f32_16x16x32_bf16 v[52:55], v[140:143], v[120:123], 0
    s_waitcnt lgkmcnt(4)
    v_mfma_f32_16x16x32_bf16 v[40:43], v[144:147], v[124:127], v[40:43]
    ds_read_b128 v[120:123], v6 offset:59392
    v_mfma_f32_16x16x32_bf16 v[44:47], v[148:151], v[124:127], v[44:47]
    v_mfma_f32_16x16x32_bf16 v[48:51], v[152:155], v[124:127], v[48:51]
    v_mfma_f32_16x16x32_bf16 v[52:55], v[156:159], v[124:127], v[52:55]
    s_waitcnt lgkmcnt(4)
    v_mfma_f32_16x16x32_bf16 v[40:43], v[160:163], v[104:107], v[40:43]
    ds_read_b128 v[124:127], v7 offset:59392
    v_mfma_f32_16x16x32_bf16 v[44:47], v[164:167], v[104:107], v[44:47]
    v_mfma_f32_16x16x32_bf16 v[48:51], v[168:171], v[104:107], v[48:51]
    v_mfma_f32_16x16x32_bf16 v[52:55], v[172:175], v[104:107], v[52:55]
    s_waitcnt lgkmcnt(4)
    v_mfma_f32_16x16x32_bf16 v[40:43], v[176:179], v[108:111], v[40:43]
    ds_read_b128 v[104:107], v6 offset:0
    v_mfma_f32_16x16x32_bf16 v[44:47], v[180:183], v[108:111], v[44:47]
    v_mfma_f32_16x16x32_bf16 v[48:51], v[184:187], v[108:111], v[48:51]
    v_mfma_f32_16x16x32_bf16 v[52:55], v[188:191], v[108:111], v[52:55]
    s_waitcnt lgkmcnt(4)
    v_mfma_f32_16x16x32_bf16 v[56:59], v[128:131], v[112:115], 0
    ds_read_b128 v[108:111], v7 offset:0
    v_mfma_f32_16x16x32_bf16 v[60:63], v[132:135], v[112:115], 0
    v_mfma_f32_16x16x32_bf16 v[64:67], v[136:139], v[112:115], 0
    v_mfma_f32_16x16x32_bf16 v[68:71], v[140:143], v[112:115], 0
    s_waitcnt lgkmcnt(4)
    v_mfma_f32_16x16x32_bf16 v[56:59], v[144:147], v[116:119], v[56:59]
    ds_read_b128 v[112:115], v6 offset:2048
    v_mfma_f32_16x16x32_bf16 v[60:63], v[148:151], v[116:119], v[60:63]
    v_mfma_f32_16x16x32_bf16 v[64:67], v[152:155], v[116:119], v[64:67]
    v_mfma_f32_16x16x32_bf16 v[68:71], v[156:159], v[116:119], v[68:71]
    s_waitcnt lgkmcnt(4)
    v_mfma_f32_16x16x32_bf16 v[56:59], v[160:163], v[120:123], v[56:59]
    ds_read_b128 v[116:119], v7 offset:2048
    v_mfma_f32_16x16x32_bf16 v[60:63], v[164:167], v[120:123], v[60:63]
    v_mfma_f32_16x16x32_bf16 v[64:67], v[168:171], v[120:123], v[64:67]
    v_mfma_f32_16x16x32_bf16 v[68:71], v[172:175], v[120:123], v[68:71]
    s_waitcnt lgkmcnt(4)
    v_mfma_f32_16x16x32_bf16 v[56:59], v[176:179], v[124:127], v[56:59]
    ds_read_b128 v[120:123], v6 offset:32768
    s_waitcnt vmcnt(8)
    v_mfma_f32_16x16x32_bf16 v[60:63], v[180:183], v[124:127], v[60:63]
    ds_read_b64_tr_b16 v[192:193], v2 offset:0
    v_mfma_f32_16x16x32_bf16 v[64:67], v[184:187], v[124:127], v[64:67]
    ds_read_b64_tr_b16 v[194:195], v2 offset:512
    v_mfma_f32_16x16x32_bf16 v[68:71], v[188:191], v[124:127], v[68:71]
    ds_read_b64_tr_b16 v[196:197], v3 offset:0
    s_waitcnt lgkmcnt(7)
    v_mfma_f32_16x16x32_bf16 v[72:75], v[128:131], v[104:107], 0
    ds_read_b128 v[124:127], v7 offset:32768
    ds_read_b64_tr_b16 v[198:199], v3 offset:512
    v_mfma_f32_16x16x32_bf16 v[76:79], v[132:135], v[104:107], 0
    ds_read_b64_tr_b16 v[200:201], v4 offset:0
    v_mfma_f32_16x16x32_bf16 v[80:83], v[136:139], v[104:107], 0
    ds_read_b64_tr_b16 v[202:203], v4 offset:512
    v_mfma_f32_16x16x32_bf16 v[84:87], v[140:143], v[104:107], 0
    ds_read_b64_tr_b16 v[204:205], v5 offset:0
    s_waitcnt lgkmcnt(11)
    v_mfma_f32_16x16x32_bf16 v[72:75], v[144:147], v[108:111], v[72:75]
    ds_read_b128 v[104:107], v6 offset:34816
    ds_read_b64_tr_b16 v[206:207], v5 offset:512
    v_mfma_f32_16x16x32_bf16 v[76:79], v[148:151], v[108:111], v[76:79]
    ds_read_b64_tr_b16 v[208:209], v2 offset:4096
    v_mfma_f32_16x16x32_bf16 v[80:83], v[152:155], v[108:111], v[80:83]
    ds_read_b64_tr_b16 v[210:211], v2 offset:4608
    v_mfma_f32_16x16x32_bf16 v[84:87], v[156:159], v[108:111], v[84:87]
    s_waitcnt lgkmcnt(14)
    ds_read_b64_tr_b16 v[212:213], v3 offset:4096
    v_mfma_f32_16x16x32_bf16 v[72:75], v[160:163], v[112:115], v[72:75]
    s_waitcnt lgkmcnt(14)
    ds_read_b128 v[108:111], v7 offset:34816
    s_waitcnt lgkmcnt(14)
    ds_read_b64_tr_b16 v[214:215], v3 offset:4608
    v_mfma_f32_16x16x32_bf16 v[76:79], v[164:167], v[112:115], v[76:79]
    s_waitcnt lgkmcnt(14)
    ds_read_b64_tr_b16 v[216:217], v4 offset:4096
    v_mfma_f32_16x16x32_bf16 v[80:83], v[168:171], v[112:115], v[80:83]
    s_waitcnt lgkmcnt(14)
    ds_read_b64_tr_b16 v[218:219], v4 offset:4608
    v_mfma_f32_16x16x32_bf16 v[84:87], v[172:175], v[112:115], v[84:87]
    s_waitcnt lgkmcnt(14)
    ds_read_b64_tr_b16 v[220:221], v5 offset:4096
    v_mfma_f32_16x16x32_bf16 v[72:75], v[176:179], v[116:119], v[72:75]
    s_waitcnt lgkmcnt(14)
    ds_read_b128 v[112:115], v6 offset:45056
    s_waitcnt lgkmcnt(14)
    ds_read_b64_tr_b16 v[222:223], v5 offset:4608
    v_mfma_f32_16x16x32_bf16 v[76:79], v[180:183], v[116:119], v[76:79]
    s_waitcnt vmcnt(0)
    v_mfma_f32_16x16x32_bf16 v[80:83], v[184:187], v[116:119], v[80:83]
    s_waitcnt lgkmcnt(14)
    ds_read_b64_tr_b16 v[224:225], v2 offset:32768
    v_mfma_f32_16x16x32_bf16 v[84:87], v[188:191], v[116:119], v[84:87]
    s_waitcnt lgkmcnt(14)
    ds_read_b64_tr_b16 v[226:227], v2 offset:33280
    v_mfma_f32_16x16x32_bf16 v[88:91], v[128:131], v[120:123], 0
    s_waitcnt lgkmcnt(14)
    ds_read_b128 v[116:119], v7 offset:45056
    s_waitcnt lgkmcnt(14)
    ds_read_b64_tr_b16 v[228:229], v3 offset:32768
    v_mfma_f32_16x16x32_bf16 v[92:95], v[132:135], v[120:123], 0
    s_waitcnt lgkmcnt(14)
    ds_read_b64_tr_b16 v[230:231], v3 offset:33280
    v_mfma_f32_16x16x32_bf16 v[96:99], v[136:139], v[120:123], 0
    s_waitcnt lgkmcnt(14)
    ds_read_b64_tr_b16 v[232:233], v4 offset:32768
    v_mfma_f32_16x16x32_bf16 v[100:103], v[140:143], v[120:123], 0
    s_waitcnt lgkmcnt(14)
    ds_read_b64_tr_b16 v[234:235], v4 offset:33280
    v_mfma_f32_16x16x32_bf16 v[88:91], v[144:147], v[124:127], v[88:91]
    s_waitcnt lgkmcnt(14)
    ds_read_b128 v[120:123], v6 offset:47104
    s_waitcnt lgkmcnt(14)
    ds_read_b64_tr_b16 v[236:237], v5 offset:32768
    v_mfma_f32_16x16x32_bf16 v[92:95], v[148:151], v[124:127], v[92:95]
    s_waitcnt lgkmcnt(14)
    ds_read_b64_tr_b16 v[238:239], v5 offset:33280
    v_mfma_f32_16x16x32_bf16 v[96:99], v[152:155], v[124:127], v[96:99]
    s_waitcnt lgkmcnt(14)
    ds_read_b64_tr_b16 v[240:241], v2 offset:36864
    v_mfma_f32_16x16x32_bf16 v[100:103], v[156:159], v[124:127], v[100:103]
    s_waitcnt lgkmcnt(14)
    ds_read_b64_tr_b16 v[242:243], v2 offset:37376
    v_mfma_f32_16x16x32_bf16 v[88:91], v[160:163], v[104:107], v[88:91]
    s_waitcnt lgkmcnt(14)
    ds_read_b128 v[124:127], v7 offset:47104
    s_waitcnt lgkmcnt(14)
    ds_read_b64_tr_b16 v[244:245], v3 offset:36864
    v_mfma_f32_16x16x32_bf16 v[92:95], v[164:167], v[104:107], v[92:95]
    s_waitcnt lgkmcnt(14)
    ds_read_b64_tr_b16 v[246:247], v3 offset:37376
    v_mfma_f32_16x16x32_bf16 v[96:99], v[168:171], v[104:107], v[96:99]
    s_waitcnt lgkmcnt(14)
    ds_read_b64_tr_b16 v[248:249], v4 offset:36864
    v_mfma_f32_16x16x32_bf16 v[100:103], v[172:175], v[104:107], v[100:103]
    s_waitcnt lgkmcnt(14)
    ds_read_b64_tr_b16 v[250:251], v4 offset:37376
    v_mfma_f32_16x16x32_bf16 v[88:91], v[176:179], v[108:111], v[88:91]
    s_waitcnt lgkmcnt(14)
    ds_read_b128 v[104:107], v6 offset:53248
    s_waitcnt lgkmcnt(14)
    ds_read_b64_tr_b16 v[252:253], v5 offset:36864
    v_mfma_f32_16x16x32_bf16 v[92:95], v[180:183], v[108:111], v[92:95]
    s_waitcnt lgkmcnt(14)
    ds_read_b64_tr_b16 v[254:255], v5 offset:37376
    v_mfma_f32_16x16x32_bf16 v[96:99], v[184:187], v[108:111], v[96:99]
    v_mfma_f32_16x16x32_bf16 v[100:103], v[188:191], v[108:111], v[100:103]
    v_mfma_f32_16x16x32_bf16 v[24:27], v[192:195], v[112:115], v[24:27]
    s_waitcnt lgkmcnt(14)
    ds_read_b128 v[108:111], v7 offset:53248
    v_mfma_f32_16x16x32_bf16 v[28:31], v[196:199], v[112:115], v[28:31]
    v_mfma_f32_16x16x32_bf16 v[32:35], v[200:203], v[112:115], v[32:35]
    v_mfma_f32_16x16x32_bf16 v[36:39], v[204:207], v[112:115], v[36:39]
    v_mfma_f32_16x16x32_bf16 v[24:27], v[208:211], v[116:119], v[24:27]
    s_waitcnt lgkmcnt(14)
    ds_read_b128 v[112:115], v6 offset:55296
    v_mfma_f32_16x16x32_bf16 v[28:31], v[212:215], v[116:119], v[28:31]
    v_mfma_f32_16x16x32_bf16 v[32:35], v[216:219], v[116:119], v[32:35]
    v_mfma_f32_16x16x32_bf16 v[36:39], v[220:223], v[116:119], v[36:39]
    s_waitcnt lgkmcnt(14)
    v_mfma_f32_16x16x32_bf16 v[24:27], v[224:227], v[120:123], v[24:27]
    ds_read_b128 v[116:119], v7 offset:55296
    v_mfma_f32_16x16x32_bf16 v[28:31], v[228:231], v[120:123], v[28:31]
    v_mfma_f32_16x16x32_bf16 v[32:35], v[232:235], v[120:123], v[32:35]
    s_waitcnt lgkmcnt(13)
    v_mfma_f32_16x16x32_bf16 v[36:39], v[236:239], v[120:123], v[36:39]
    s_waitcnt lgkmcnt(10)
    v_mfma_f32_16x16x32_bf16 v[24:27], v[240:243], v[124:127], v[24:27]
    ds_read_b128 v[120:123], v6 offset:61440
    s_waitcnt lgkmcnt(9)
    v_mfma_f32_16x16x32_bf16 v[28:31], v[244:247], v[124:127], v[28:31]
    s_waitcnt lgkmcnt(7)
    v_mfma_f32_16x16x32_bf16 v[32:35], v[248:251], v[124:127], v[32:35]
    s_waitcnt lgkmcnt(4)
    v_mfma_f32_16x16x32_bf16 v[36:39], v[252:255], v[124:127], v[36:39]
    v_mfma_f32_16x16x32_bf16 v[40:43], v[192:195], v[104:107], v[40:43]
    ds_read_b128 v[124:127], v7 offset:61440
    v_mfma_f32_16x16x32_bf16 v[44:47], v[196:199], v[104:107], v[44:47]
    v_mfma_f32_16x16x32_bf16 v[48:51], v[200:203], v[104:107], v[48:51]
    v_mul_f32 v24, v10, v24
    v_mul_f32 v25, v10, v25
    v_mfma_f32_16x16x32_bf16 v[52:55], v[204:207], v[104:107], v[52:55]
    v_mul_f32 v26, v10, v26
    v_mul_f32 v27, v10, v27
    s_waitcnt lgkmcnt(4)
    v_mfma_f32_16x16x32_bf16 v[40:43], v[208:211], v[108:111], v[40:43]
    ds_read_b128 v[104:107], v6 offset:63488
    v_mul_f32 v28, v10, v28
    v_mul_f32 v29, v10, v29
    v_mfma_f32_16x16x32_bf16 v[44:47], v[212:215], v[108:111], v[44:47]
    v_mul_f32 v30, v10, v30
    v_mul_f32 v31, v10, v31
    v_mfma_f32_16x16x32_bf16 v[48:51], v[216:219], v[108:111], v[48:51]
    v_cvt_pk_bf16_f32 v24, v24, v25
    v_cvt_pk_bf16_f32 v25, v26, v27
    v_mfma_f32_16x16x32_bf16 v[52:55], v[220:223], v[108:111], v[52:55]
    v_cvt_pk_bf16_f32 v26, v28, v29
    v_cvt_pk_bf16_f32 v27, v30, v31
    s_waitcnt lgkmcnt(4)
    v_mfma_f32_16x16x32_bf16 v[40:43], v[224:227], v[112:115], v[40:43]
    ds_read_b128 v[108:111], v7 offset:63488
    buffer_store_dwordx4 v[24:27], v17, s[48:51], s26 offen offset:0 sc1
    v_mfma_f32_16x16x32_bf16 v[44:47], v[228:231], v[112:115], v[44:47]
    v_mul_f32 v32, v10, v32
    v_mul_f32 v33, v10, v33
    v_mfma_f32_16x16x32_bf16 v[48:51], v[232:235], v[112:115], v[48:51]
    v_mul_f32 v34, v10, v34
    v_mul_f32 v35, v10, v35
    v_mfma_f32_16x16x32_bf16 v[52:55], v[236:239], v[112:115], v[52:55]
    v_mul_f32 v36, v10, v36
    v_mul_f32 v37, v10, v37
    s_waitcnt lgkmcnt(4)
    v_mfma_f32_16x16x32_bf16 v[40:43], v[240:243], v[116:119], v[40:43]
    ds_read_b128 v[112:115], v6 offset:4096
    v_mul_f32 v38, v10, v38
    v_mul_f32 v39, v10, v39
    v_mfma_f32_16x16x32_bf16 v[44:47], v[244:247], v[116:119], v[44:47]
    v_cvt_pk_bf16_f32 v32, v32, v33
    v_cvt_pk_bf16_f32 v33, v34, v35
    v_mfma_f32_16x16x32_bf16 v[48:51], v[248:251], v[116:119], v[48:51]
    v_cvt_pk_bf16_f32 v34, v36, v37
    v_cvt_pk_bf16_f32 v35, v38, v39
    v_mfma_f32_16x16x32_bf16 v[52:55], v[252:255], v[116:119], v[52:55]
    buffer_store_dwordx4 v[32:35], v17, s[48:51], s26 offen offset:1024 sc1
    s_waitcnt lgkmcnt(4)
    v_mfma_f32_16x16x32_bf16 v[56:59], v[192:195], v[120:123], v[56:59]
    ds_read_b128 v[116:119], v7 offset:4096
    v_mfma_f32_16x16x32_bf16 v[60:63], v[196:199], v[120:123], v[60:63]
    v_mfma_f32_16x16x32_bf16 v[64:67], v[200:203], v[120:123], v[64:67]
    v_mul_f32 v40, v11, v40
    v_mul_f32 v41, v11, v41
    v_mfma_f32_16x16x32_bf16 v[68:71], v[204:207], v[120:123], v[68:71]
    v_mul_f32 v42, v11, v42
    v_mul_f32 v43, v11, v43
    s_waitcnt lgkmcnt(4)
    v_mfma_f32_16x16x32_bf16 v[56:59], v[208:211], v[124:127], v[56:59]
    ds_read_b128 v[120:123], v6 offset:6144
    v_mul_f32 v44, v11, v44
    v_mul_f32 v45, v11, v45
    v_mfma_f32_16x16x32_bf16 v[60:63], v[212:215], v[124:127], v[60:63]
    v_mul_f32 v46, v11, v46
    v_mul_f32 v47, v11, v47
    v_mfma_f32_16x16x32_bf16 v[64:67], v[216:219], v[124:127], v[64:67]
    v_cvt_pk_bf16_f32 v40, v40, v41
    v_cvt_pk_bf16_f32 v41, v42, v43
    v_mfma_f32_16x16x32_bf16 v[68:71], v[220:223], v[124:127], v[68:71]
    v_cvt_pk_bf16_f32 v42, v44, v45
    v_cvt_pk_bf16_f32 v43, v46, v47
    s_waitcnt lgkmcnt(4)
    v_mfma_f32_16x16x32_bf16 v[56:59], v[224:227], v[104:107], v[56:59]
    ds_read_b128 v[124:127], v7 offset:6144
    buffer_store_dwordx4 v[40:43], v17, s[48:51], s26 offen offset:2048 sc1
    v_mfma_f32_16x16x32_bf16 v[60:63], v[228:231], v[104:107], v[60:63]
    v_mul_f32 v48, v11, v48
    v_mul_f32 v49, v11, v49
    v_mfma_f32_16x16x32_bf16 v[64:67], v[232:235], v[104:107], v[64:67]
    v_mul_f32 v50, v11, v50
    v_mul_f32 v51, v11, v51
    v_mfma_f32_16x16x32_bf16 v[68:71], v[236:239], v[104:107], v[68:71]
    v_mul_f32 v52, v11, v52
    v_mul_f32 v53, v11, v53
    s_waitcnt lgkmcnt(4)
    v_mfma_f32_16x16x32_bf16 v[56:59], v[240:243], v[108:111], v[56:59]
    ds_read_b128 v[104:107], v6 offset:36864
    v_mul_f32 v54, v11, v54
    v_mul_f32 v55, v11, v55
    v_mfma_f32_16x16x32_bf16 v[60:63], v[244:247], v[108:111], v[60:63]
    v_cvt_pk_bf16_f32 v48, v48, v49
    v_cvt_pk_bf16_f32 v49, v50, v51
    v_mfma_f32_16x16x32_bf16 v[64:67], v[248:251], v[108:111], v[64:67]
    v_cvt_pk_bf16_f32 v50, v52, v53
    v_cvt_pk_bf16_f32 v51, v54, v55
    v_mfma_f32_16x16x32_bf16 v[68:71], v[252:255], v[108:111], v[68:71]
    buffer_store_dwordx4 v[48:51], v17, s[48:51], s26 offen offset:3072 sc1
    s_waitcnt lgkmcnt(4)
    v_mfma_f32_16x16x32_bf16 v[72:75], v[192:195], v[112:115], v[72:75]
    ds_read_b128 v[108:111], v7 offset:36864
    v_mfma_f32_16x16x32_bf16 v[76:79], v[196:199], v[112:115], v[76:79]
    v_mfma_f32_16x16x32_bf16 v[80:83], v[200:203], v[112:115], v[80:83]
    v_mul_f32 v56, v12, v56
    v_mul_f32 v57, v12, v57
    v_mfma_f32_16x16x32_bf16 v[84:87], v[204:207], v[112:115], v[84:87]
    v_mul_f32 v58, v12, v58
    v_mul_f32 v59, v12, v59
    s_waitcnt lgkmcnt(4)
    v_mfma_f32_16x16x32_bf16 v[72:75], v[208:211], v[116:119], v[72:75]
    ds_read_b128 v[112:115], v6 offset:38912
    v_mul_f32 v60, v12, v60
    v_mul_f32 v61, v12, v61
    v_mfma_f32_16x16x32_bf16 v[76:79], v[212:215], v[116:119], v[76:79]
    v_mul_f32 v62, v12, v62
    v_mul_f32 v63, v12, v63
    v_mfma_f32_16x16x32_bf16 v[80:83], v[216:219], v[116:119], v[80:83]
    v_cvt_pk_bf16_f32 v56, v56, v57
    v_cvt_pk_bf16_f32 v57, v58, v59
    v_mfma_f32_16x16x32_bf16 v[84:87], v[220:223], v[116:119], v[84:87]
    v_cvt_pk_bf16_f32 v58, v60, v61
    v_cvt_pk_bf16_f32 v59, v62, v63
    s_waitcnt lgkmcnt(4)
    v_mfma_f32_16x16x32_bf16 v[72:75], v[224:227], v[120:123], v[72:75]
    ds_read_b128 v[116:119], v7 offset:38912
    buffer_store_dwordx4 v[56:59], v17, s[48:51], s27 offen offset:0 sc1
    v_mfma_f32_16x16x32_bf16 v[76:79], v[228:231], v[120:123], v[76:79]
    v_mul_f32 v64, v12, v64
    v_mul_f32 v65, v12, v65
    v_mfma_f32_16x16x32_bf16 v[80:83], v[232:235], v[120:123], v[80:83]
    v_mul_f32 v66, v12, v66
    v_mul_f32 v67, v12, v67
    v_mfma_f32_16x16x32_bf16 v[84:87], v[236:239], v[120:123], v[84:87]
    v_mul_f32 v68, v12, v68
    v_mul_f32 v69, v12, v69
    s_waitcnt lgkmcnt(4)
    v_mfma_f32_16x16x32_bf16 v[72:75], v[240:243], v[124:127], v[72:75]
    v_mul_f32 v70, v12, v70
    v_mul_f32 v71, v12, v71
    v_mfma_f32_16x16x32_bf16 v[76:79], v[244:247], v[124:127], v[76:79]
    v_cvt_pk_bf16_f32 v64, v64, v65
    v_cvt_pk_bf16_f32 v65, v66, v67
    v_mfma_f32_16x16x32_bf16 v[80:83], v[248:251], v[124:127], v[80:83]
    v_cvt_pk_bf16_f32 v66, v68, v69
    v_cvt_pk_bf16_f32 v67, v70, v71
    v_mfma_f32_16x16x32_bf16 v[84:87], v[252:255], v[124:127], v[84:87]
    buffer_store_dwordx4 v[64:67], v17, s[48:51], s27 offen offset:1024 sc1
    s_waitcnt lgkmcnt(3)
    v_mfma_f32_16x16x32_bf16 v[88:91], v[192:195], v[104:107], v[88:91]
    v_mfma_f32_16x16x32_bf16 v[92:95], v[196:199], v[104:107], v[92:95]
    v_mfma_f32_16x16x32_bf16 v[96:99], v[200:203], v[104:107], v[96:99]
    v_mul_f32 v72, v13, v72
    v_mul_f32 v73, v13, v73
    v_mfma_f32_16x16x32_bf16 v[100:103], v[204:207], v[104:107], v[100:103]
    v_mul_f32 v74, v13, v74
    v_mul_f32 v75, v13, v75
    s_waitcnt lgkmcnt(2)
    v_mfma_f32_16x16x32_bf16 v[88:91], v[208:211], v[108:111], v[88:91]
    v_mul_f32 v76, v13, v76
    v_mul_f32 v77, v13, v77
    v_mfma_f32_16x16x32_bf16 v[92:95], v[212:215], v[108:111], v[92:95]
    v_mul_f32 v78, v13, v78
    v_mul_f32 v79, v13, v79
    v_mfma_f32_16x16x32_bf16 v[96:99], v[216:219], v[108:111], v[96:99]
    v_cvt_pk_bf16_f32 v72, v72, v73
    v_cvt_pk_bf16_f32 v73, v74, v75
    v_mfma_f32_16x16x32_bf16 v[100:103], v[220:223], v[108:111], v[100:103]
    v_cvt_pk_bf16_f32 v74, v76, v77
    v_cvt_pk_bf16_f32 v75, v78, v79
    s_waitcnt lgkmcnt(1)
    v_mfma_f32_16x16x32_bf16 v[88:91], v[224:227], v[112:115], v[88:91]
    buffer_store_dwordx4 v[72:75], v17, s[48:51], s27 offen offset:2048 sc1
    v_mfma_f32_16x16x32_bf16 v[92:95], v[228:231], v[112:115], v[92:95]
    v_mul_f32 v80, v13, v80
    v_mul_f32 v81, v13, v81
    v_mfma_f32_16x16x32_bf16 v[96:99], v[232:235], v[112:115], v[96:99]
    v_mul_f32 v82, v13, v82
    v_mul_f32 v83, v13, v83
    v_mfma_f32_16x16x32_bf16 v[100:103], v[236:239], v[112:115], v[100:103]
    v_mul_f32 v84, v13, v84
    v_mul_f32 v85, v13, v85
    s_waitcnt lgkmcnt(0)
    v_mfma_f32_16x16x32_bf16 v[88:91], v[240:243], v[116:119], v[88:91]
    v_mul_f32 v86, v13, v86
    v_mul_f32 v87, v13, v87
    v_mfma_f32_16x16x32_bf16 v[92:95], v[244:247], v[116:119], v[92:95]
    v_cvt_pk_bf16_f32 v80, v80, v81
    v_cvt_pk_bf16_f32 v81, v82, v83
    v_mfma_f32_16x16x32_bf16 v[96:99], v[248:251], v[116:119], v[96:99]
    v_cvt_pk_bf16_f32 v82, v84, v85
    v_cvt_pk_bf16_f32 v83, v86, v87
    v_mfma_f32_16x16x32_bf16 v[100:103], v[252:255], v[116:119], v[100:103]
    buffer_store_dwordx4 v[80:83], v17, s[48:51], s27 offen offset:3072 sc1
    v_mul_f32 v88, v14, v88
    v_mul_f32 v89, v14, v89
    v_mul_f32 v90, v14, v90
    v_mul_f32 v91, v14, v91
    v_mul_f32 v92, v14, v92
    v_mul_f32 v93, v14, v93
    v_mul_f32 v94, v14, v94
    v_mul_f32 v95, v14, v95
    v_cvt_pk_bf16_f32 v88, v88, v89
    v_cvt_pk_bf16_f32 v89, v90, v91
    v_cvt_pk_bf16_f32 v90, v92, v93
    v_cvt_pk_bf16_f32 v91, v94, v95
    buffer_store_dwordx4 v[88:91], v17, s[48:51], s28 offen offset:0 sc1
    v_mul_f32 v96, v14, v96
    v_mul_f32 v97, v14, v97
    v_mul_f32 v98, v14, v98
    v_mul_f32 v99, v14, v99
    v_mul_f32 v100, v14, v100
    v_mul_f32 v101, v14, v101
    v_mul_f32 v102, v14, v102
    v_mul_f32 v103, v14, v103
    v_cvt_pk_bf16_f32 v96, v96, v97
    v_cvt_pk_bf16_f32 v97, v98, v99
    v_cvt_pk_bf16_f32 v98, v100, v101
    v_cvt_pk_bf16_f32 v99, v102, v103
    buffer_store_dwordx4 v[96:99], v17, s[48:51], s28 offen offset:1024 sc1
    s_branch L_opub
L_oproj_q:
    ds_read_b128 v[104:107], v6 offset:40960
    ds_read_b128 v[108:111], v7 offset:40960
    ds_read_b128 v[112:115], v6 offset:43008
    ds_read_b128 v[116:119], v7 offset:43008
    ds_read_b128 v[120:123], v6 offset:49152
    v_lshlrev_b32 v17, 4, v1
    s_mul_i32 s26, s58, 10240
    s_add_u32 s27, s26, 4096
    s_add_u32 s28, s26, 8192
    s_waitcnt lgkmcnt(4)
    v_mfma_f32_16x16x32_bf16 v[24:27], v[128:131], v[104:107], 0
    ds_read_b128 v[124:127], v7 offset:49152
    s_add_u32 m0, s55, 32768
    v_mfma_f32_16x16x32_bf16 v[28:31], v[132:135], v[104:107], 0
    buffer_load_dwordx4 v8, s[32:35], s52 offen lds
    v_mfma_f32_16x16x32_bf16 v[32:35], v[136:139], v[104:107], 0
    v_mfma_f32_16x16x32_bf16 v[36:39], v[140:143], v[104:107], 0
    buffer_load_dwordx4 v9, s[32:35], s52 offen offset:1024 lds
    s_add_u32 s52, s52, s53
    s_waitcnt lgkmcnt(4)
    v_mfma_f32_16x16x32_bf16 v[24:27], v[144:147], v[108:111], v[24:27]
    ds_read_b128 v[104:107], v6 offset:51200
    s_add_u32 m0, s55, 34816
    v_mfma_f32_16x16x32_bf16 v[28:31], v[148:151], v[108:111], v[28:31]
    buffer_load_dwordx4 v8, s[32:35], s52 offen lds
    v_mfma_f32_16x16x32_bf16 v[32:35], v[152:155], v[108:111], v[32:35]
    v_mfma_f32_16x16x32_bf16 v[36:39], v[156:159], v[108:111], v[36:39]
    buffer_load_dwordx4 v9, s[32:35], s52 offen offset:1024 lds
    s_add_u32 s52, s52, s53
    s_waitcnt lgkmcnt(4)
    v_mfma_f32_16x16x32_bf16 v[24:27], v[160:163], v[112:115], v[24:27]
    ds_read_b128 v[108:111], v7 offset:51200
    s_add_u32 m0, s55, 36864
    v_mfma_f32_16x16x32_bf16 v[28:31], v[164:167], v[112:115], v[28:31]
    buffer_load_dwordx4 v8, s[32:35], s52 offen lds
    v_mfma_f32_16x16x32_bf16 v[32:35], v[168:171], v[112:115], v[32:35]
    v_mfma_f32_16x16x32_bf16 v[36:39], v[172:175], v[112:115], v[36:39]
    buffer_load_dwordx4 v9, s[32:35], s52 offen offset:1024 lds
    s_add_u32 s52, s52, s53
    s_waitcnt lgkmcnt(4)
    v_mfma_f32_16x16x32_bf16 v[24:27], v[176:179], v[116:119], v[24:27]
    ds_read_b128 v[112:115], v6 offset:57344
    s_add_u32 m0, s55, 38912
    v_mfma_f32_16x16x32_bf16 v[28:31], v[180:183], v[116:119], v[28:31]
    buffer_load_dwordx4 v8, s[32:35], s52 offen lds
    v_mfma_f32_16x16x32_bf16 v[32:35], v[184:187], v[116:119], v[32:35]
    v_mfma_f32_16x16x32_bf16 v[36:39], v[188:191], v[116:119], v[36:39]
    buffer_load_dwordx4 v9, s[32:35], s52 offen offset:1024 lds
    s_and_b32 s52, s90, 15
    s_lshr_b64 s[90:91], s[90:91], 4
    s_mul_i32 s52, s52, s54
    s_add_u32 s52, s52, s57
    s_waitcnt lgkmcnt(4)
    v_mfma_f32_16x16x32_bf16 v[40:43], v[128:131], v[120:123], 0
    ds_read_b128 v[116:119], v7 offset:57344
    v_mfma_f32_16x16x32_bf16 v[44:47], v[132:135], v[120:123], 0
    v_mfma_f32_16x16x32_bf16 v[48:51], v[136:139], v[120:123], 0
    v_mfma_f32_16x16x32_bf16 v[52:55], v[140:143], v[120:123], 0
    s_waitcnt lgkmcnt(4)
    v_mfma_f32_16x16x32_bf16 v[40:43], v[144:147], v[124:127], v[40:43]
    ds_read_b128 v[120:123], v6 offset:59392
    v_mfma_f32_16x16x32_bf16 v[44:47], v[148:151], v[124:127], v[44:47]
    v_mfma_f32_16x16x32_bf16 v[48:51], v[152:155], v[124:127], v[48:51]
    v_mfma_f32_16x16x32_bf16 v[52:55], v[156:159], v[124:127], v[52:55]
    s_waitcnt lgkmcnt(4)
    v_mfma_f32_16x16x32_bf16 v[40:43], v[160:163], v[104:107], v[40:43]
    ds_read_b128 v[124:127], v7 offset:59392
    v_mfma_f32_16x16x32_bf16 v[44:47], v[164:167], v[104:107], v[44:47]
    v_mfma_f32_16x16x32_bf16 v[48:51], v[168:171], v[104:107], v[48:51]
    v_mfma_f32_16x16x32_bf16 v[52:55], v[172:175], v[104:107], v[52:55]
    s_waitcnt lgkmcnt(4)
    v_mfma_f32_16x16x32_bf16 v[40:43], v[176:179], v[108:111], v[40:43]
    ds_read_b128 v[104:107], v6 offset:0
    v_mfma_f32_16x16x32_bf16 v[44:47], v[180:183], v[108:111], v[44:47]
    v_mfma_f32_16x16x32_bf16 v[48:51], v[184:187], v[108:111], v[48:51]
    v_mfma_f32_16x16x32_bf16 v[52:55], v[188:191], v[108:111], v[52:55]
    s_waitcnt lgkmcnt(4)
    v_mfma_f32_16x16x32_bf16 v[56:59], v[128:131], v[112:115], 0
    ds_read_b128 v[108:111], v7 offset:0
    v_mfma_f32_16x16x32_bf16 v[60:63], v[132:135], v[112:115], 0
    v_mfma_f32_16x16x32_bf16 v[64:67], v[136:139], v[112:115], 0
    v_mfma_f32_16x16x32_bf16 v[68:71], v[140:143], v[112:115], 0
    s_waitcnt lgkmcnt(4)
    v_mfma_f32_16x16x32_bf16 v[56:59], v[144:147], v[116:119], v[56:59]
    ds_read_b128 v[112:115], v6 offset:2048
    v_mfma_f32_16x16x32_bf16 v[60:63], v[148:151], v[116:119], v[60:63]
    v_mfma_f32_16x16x32_bf16 v[64:67], v[152:155], v[116:119], v[64:67]
    v_mfma_f32_16x16x32_bf16 v[68:71], v[156:159], v[116:119], v[68:71]
    s_waitcnt lgkmcnt(4)
    v_mfma_f32_16x16x32_bf16 v[56:59], v[160:163], v[120:123], v[56:59]
    ds_read_b128 v[116:119], v7 offset:2048
    v_mfma_f32_16x16x32_bf16 v[60:63], v[164:167], v[120:123], v[60:63]
    v_mfma_f32_16x16x32_bf16 v[64:67], v[168:171], v[120:123], v[64:67]
    v_mfma_f32_16x16x32_bf16 v[68:71], v[172:175], v[120:123], v[68:71]
    s_waitcnt lgkmcnt(4)
    v_mfma_f32_16x16x32_bf16 v[56:59], v[176:179], v[124:127], v[56:59]
    ds_read_b128 v[120:123], v6 offset:32768
    s_waitcnt vmcnt(8)
    v_mfma_f32_16x16x32_bf16 v[60:63], v[180:183], v[124:127], v[60:63]
    ds_read_b64_tr_b16 v[192:193], v2 offset:0
    v_mfma_f32_16x16x32_bf16 v[64:67], v[184:187], v[124:127], v[64:67]
    ds_read_b64_tr_b16 v[194:195], v2 offset:512
    v_mfma_f32_16x16x32_bf16 v[68:71], v[188:191], v[124:127], v[68:71]
    ds_read_b64_tr_b16 v[196:197], v3 offset:0
    s_waitcnt lgkmcnt(7)
    v_mfma_f32_16x16x32_bf16 v[72:75], v[128:131], v[104:107], 0
    ds_read_b128 v[124:127], v7 offset:32768
    ds_read_b64_tr_b16 v[198:199], v3 offset:512
    v_mfma_f32_16x16x32_bf16 v[76:79], v[132:135], v[104:107], 0
    ds_read_b64_tr_b16 v[200:201], v4 offset:0
    v_mfma_f32_16x16x32_bf16 v[80:83], v[136:139], v[104:107], 0
    ds_read_b64_tr_b16 v[202:203], v4 offset:512
    v_mfma_f32_16x16x32_bf16 v[84:87], v[140:143], v[104:107], 0
    ds_read_b64_tr_b16 v[204:205], v5 offset:0
    s_waitcnt lgkmcnt(11)
    v_mfma_f32_16x16x32_bf16 v[72:75], v[144:147], v[108:111], v[72:75]
    ds_read_b128 v[104:107], v6 offset:34816
    ds_read_b64_tr_b16 v[206:207], v5 offset:512
    v_mfma_f32_16x16x32_bf16 v[76:79], v[148:151], v[108:111], v[76:79]
    ds_read_b64_tr_b16 v[208:209], v2 offset:4096
    v_mfma_f32_16x16x32_bf16 v[80:83], v[152:155], v[108:111], v[80:83]
    ds_read_b64_tr_b16 v[210:211], v2 offset:4608
    v_mfma_f32_16x16x32_bf16 v[84:87], v[156:159], v[108:111], v[84:87]
    s_waitcnt lgkmcnt(14)
    ds_read_b64_tr_b16 v[212:213], v3 offset:4096
    v_mfma_f32_16x16x32_bf16 v[72:75], v[160:163], v[112:115], v[72:75]
    s_waitcnt lgkmcnt(14)
    ds_read_b128 v[108:111], v7 offset:34816
    s_waitcnt lgkmcnt(14)
    ds_read_b64_tr_b16 v[214:215], v3 offset:4608
    v_mfma_f32_16x16x32_bf16 v[76:79], v[164:167], v[112:115], v[76:79]
    s_waitcnt lgkmcnt(14)
    ds_read_b64_tr_b16 v[216:217], v4 offset:4096
    v_mfma_f32_16x16x32_bf16 v[80:83], v[168:171], v[112:115], v[80:83]
    s_waitcnt lgkmcnt(14)
    ds_read_b64_tr_b16 v[218:219], v4 offset:4608
    v_mfma_f32_16x16x32_bf16 v[84:87], v[172:175], v[112:115], v[84:87]
    s_waitcnt lgkmcnt(14)
    ds_read_b64_tr_b16 v[220:221], v5 offset:4096
    v_mfma_f32_16x16x32_bf16 v[72:75], v[176:179], v[116:119], v[72:75]
    s_waitcnt lgkmcnt(14)
    ds_read_b128 v[112:115], v6 offset:45056
    s_waitcnt lgkmcnt(14)
    ds_read_b64_tr_b16 v[222:223], v5 offset:4608
    v_mfma_f32_16x16x32_bf16 v[76:79], v[180:183], v[116:119], v[76:79]
    s_waitcnt vmcnt(0)
    v_mfma_f32_16x16x32_bf16 v[80:83], v[184:187], v[116:119], v[80:83]
    s_waitcnt lgkmcnt(14)
    ds_read_b64_tr_b16 v[224:225], v2 offset:32768
    v_mfma_f32_16x16x32_bf16 v[84:87], v[188:191], v[116:119], v[84:87]
    s_waitcnt lgkmcnt(14)
    ds_read_b64_tr_b16 v[226:227], v2 offset:33280
    v_mfma_f32_16x16x32_bf16 v[88:91], v[128:131], v[120:123], 0
    s_waitcnt lgkmcnt(14)
    ds_read_b128 v[116:119], v7 offset:45056
    s_waitcnt lgkmcnt(14)
    ds_read_b64_tr_b16 v[228:229], v3 offset:32768
    v_mfma_f32_16x16x32_bf16 v[92:95], v[132:135], v[120:123], 0
    s_waitcnt lgkmcnt(14)
    ds_read_b64_tr_b16 v[230:231], v3 offset:33280
    v_mfma_f32_16x16x32_bf16 v[96:99], v[136:139], v[120:123], 0
    s_waitcnt lgkmcnt(14)
    ds_read_b64_tr_b16 v[232:233], v4 offset:32768
    v_mfma_f32_16x16x32_bf16 v[100:103], v[140:143], v[120:123], 0
    s_waitcnt lgkmcnt(14)
    ds_read_b64_tr_b16 v[234:235], v4 offset:33280
    v_mfma_f32_16x16x32_bf16 v[88:91], v[144:147], v[124:127], v[88:91]
    s_waitcnt lgkmcnt(14)
    ds_read_b128 v[120:123], v6 offset:47104
    s_waitcnt lgkmcnt(14)
    ds_read_b64_tr_b16 v[236:237], v5 offset:32768
    v_mfma_f32_16x16x32_bf16 v[92:95], v[148:151], v[124:127], v[92:95]
    s_waitcnt lgkmcnt(14)
    ds_read_b64_tr_b16 v[238:239], v5 offset:33280
    v_mfma_f32_16x16x32_bf16 v[96:99], v[152:155], v[124:127], v[96:99]
    s_waitcnt lgkmcnt(14)
    ds_read_b64_tr_b16 v[240:241], v2 offset:36864
    v_mfma_f32_16x16x32_bf16 v[100:103], v[156:159], v[124:127], v[100:103]
    s_waitcnt lgkmcnt(14)
    ds_read_b64_tr_b16 v[242:243], v2 offset:37376
    v_mfma_f32_16x16x32_bf16 v[88:91], v[160:163], v[104:107], v[88:91]
    s_waitcnt lgkmcnt(14)
    ds_read_b128 v[124:127], v7 offset:47104
    s_waitcnt lgkmcnt(14)
    ds_read_b64_tr_b16 v[244:245], v3 offset:36864
    v_mfma_f32_16x16x32_bf16 v[92:95], v[164:167], v[104:107], v[92:95]
    s_waitcnt lgkmcnt(14)
    ds_read_b64_tr_b16 v[246:247], v3 offset:37376
    v_mfma_f32_16x16x32_bf16 v[96:99], v[168:171], v[104:107], v[96:99]
    s_waitcnt lgkmcnt(14)
    ds_read_b64_tr_b16 v[248:249], v4 offset:36864
    v_mfma_f32_16x16x32_bf16 v[100:103], v[172:175], v[104:107], v[100:103]
    s_waitcnt lgkmcnt(14)
    ds_read_b64_tr_b16 v[250:251], v4 offset:37376
    v_mfma_f32_16x16x32_bf16 v[88:91], v[176:179], v[108:111], v[88:91]
    s_waitcnt lgkmcnt(14)
    ds_read_b128 v[104:107], v6 offset:53248
    s_waitcnt lgkmcnt(14)
    ds_read_b64_tr_b16 v[252:253], v5 offset:36864
    v_mfma_f32_16x16x32_bf16 v[92:95], v[180:183], v[108:111], v[92:95]
    s_waitcnt lgkmcnt(14)
    ds_read_b64_tr_b16 v[254:255], v5 offset:37376
    v_mfma_f32_16x16x32_bf16 v[96:99], v[184:187], v[108:111], v[96:99]
    v_mfma_f32_16x16x32_bf16 v[100:103], v[188:191], v[108:111], v[100:103]
    v_mfma_f32_16x16x32_bf16 v[24:27], v[192:195], v[112:115], v[24:27]
    s_waitcnt lgkmcnt(14)
    ds_read_b128 v[108:111], v7 offset:53248
    v_mfma_f32_16x16x32_bf16 v[28:31], v[196:199], v[112:115], v[28:31]
    v_mfma_f32_16x16x32_bf16 v[32:35], v[200:203], v[112:115], v[32:35]
    v_mfma_f32_16x16x32_bf16 v[36:39], v[204:207], v[112:115], v[36:39]
    v_mfma_f32_16x16x32_bf16 v[24:27], v[208:211], v[116:119], v[24:27]
    s_waitcnt lgkmcnt(14)
    ds_read_b128 v[112:115], v6 offset:55296
    v_mfma_f32_16x16x32_bf16 v[28:31], v[212:215], v[116:119], v[28:31]
    v_mfma_f32_16x16x32_bf16 v[32:35], v[216:219], v[116:119], v[32:35]
    v_mfma_f32_16x16x32_bf16 v[36:39], v[220:223], v[116:119], v[36:39]
    s_waitcnt lgkmcnt(14)
    v_mfma_f32_16x16x32_bf16 v[24:27], v[224:227], v[120:123], v[24:27]
    ds_read_b128 v[116:119], v7 offset:55296
    v_mfma_f32_16x16x32_bf16 v[28:31], v[228:231], v[120:123], v[28:31]
    v_mfma_f32_16x16x32_bf16 v[32:35], v[232:235], v[120:123], v[32:35]
    s_waitcnt lgkmcnt(13)
    v_mfma_f32_16x16x32_bf16 v[36:39], v[236:239], v[120:123], v[36:39]
    s_waitcnt lgkmcnt(10)
    v_mfma_f32_16x16x32_bf16 v[24:27], v[240:243], v[124:127], v[24:27]
    ds_read_b128 v[120:123], v6 offset:61440
    s_waitcnt lgkmcnt(9)
    v_mfma_f32_16x16x32_bf16 v[28:31], v[244:247], v[124:127], v[28:31]
    s_waitcnt lgkmcnt(7)
    v_mfma_f32_16x16x32_bf16 v[32:35], v[248:251], v[124:127], v[32:35]
    s_waitcnt lgkmcnt(4)
    v_mfma_f32_16x16x32_bf16 v[36:39], v[252:255], v[124:127], v[36:39]
    v_mfma_f32_16x16x32_bf16 v[40:43], v[192:195], v[104:107], v[40:43]
    ds_read_b128 v[124:127], v7 offset:61440
    v_mfma_f32_16x16x32_bf16 v[44:47], v[196:199], v[104:107], v[44:47]
    v_mfma_f32_16x16x32_bf16 v[48:51], v[200:203], v[104:107], v[48:51]
    v_mul_f32 v24, v10, v24
    v_mul_f32 v25, v10, v25
    v_mfma_f32_16x16x32_bf16 v[52:55], v[204:207], v[104:107], v[52:55]
    v_mul_f32 v26, v10, v26
    v_mul_f32 v27, v10, v27
    s_waitcnt lgkmcnt(4)
    v_mfma_f32_16x16x32_bf16 v[40:43], v[208:211], v[108:111], v[40:43]
    ds_read_b128 v[104:107], v6 offset:63488
    v_mul_f32 v28, v10, v28
    v_mul_f32 v29, v10, v29
    v_mfma_f32_16x16x32_bf16 v[44:47], v[212:215], v[108:111], v[44:47]
    v_mul_f32 v30, v10, v30
    v_mul_f32 v31, v10, v31
    v_mfma_f32_16x16x32_bf16 v[48:51], v[216:219], v[108:111], v[48:51]
    v_cvt_pk_bf16_f32 v24, v24, v25
    v_cvt_pk_bf16_f32 v25, v26, v27
    v_mfma_f32_16x16x32_bf16 v[52:55], v[220:223], v[108:111], v[52:55]
    v_cvt_pk_bf16_f32 v26, v28, v29
    v_cvt_pk_bf16_f32 v27, v30, v31
    s_waitcnt lgkmcnt(4)
    v_mfma_f32_16x16x32_bf16 v[40:43], v[224:227], v[112:115], v[40:43]
    ds_read_b128 v[108:111], v7 offset:63488
    buffer_store_dwordx4 v[24:27], v17, s[48:51], s26 offen offset:0 sc1
    v_mfma_f32_16x16x32_bf16 v[44:47], v[228:231], v[112:115], v[44:47]
    v_mul_f32 v32, v10, v32
    v_mul_f32 v33, v10, v33
    v_mfma_f32_16x16x32_bf16 v[48:51], v[232:235], v[112:115], v[48:51]
    v_mul_f32 v34, v10, v34
    v_mul_f32 v35, v10, v35
    v_mfma_f32_16x16x32_bf16 v[52:55], v[236:239], v[112:115], v[52:55]
    v_mul_f32 v36, v10, v36
    v_mul_f32 v37, v10, v37
    s_waitcnt lgkmcnt(4)
    v_mfma_f32_16x16x32_bf16 v[40:43], v[240:243], v[116:119], v[40:43]
    ds_read_b128 v[112:115], v6 offset:4096
    v_mul_f32 v38, v10, v38
    v_mul_f32 v39, v10, v39
    v_mfma_f32_16x16x32_bf16 v[44:47], v[244:247], v[116:119], v[44:47]
    v_cvt_pk_bf16_f32 v32, v32, v33
    v_cvt_pk_bf16_f32 v33, v34, v35
    v_mfma_f32_16x16x32_bf16 v[48:51], v[248:251], v[116:119], v[48:51]
    v_cvt_pk_bf16_f32 v34, v36, v37
    v_cvt_pk_bf16_f32 v35, v38, v39
    v_mfma_f32_16x16x32_bf16 v[52:55], v[252:255], v[116:119], v[52:55]
    buffer_store_dwordx4 v[32:35], v17, s[48:51], s26 offen offset:1024 sc1
    s_waitcnt lgkmcnt(4)
    v_mfma_f32_16x16x32_bf16 v[56:59], v[192:195], v[120:123], v[56:59]
    ds_read_b128 v[116:119], v7 offset:4096
    v_mfma_f32_16x16x32_bf16 v[60:63], v[196:199], v[120:123], v[60:63]
    v_mfma_f32_16x16x32_bf16 v[64:67], v[200:203], v[120:123], v[64:67]
    v_mul_f32 v40, v11, v40
    v_mul_f32 v41, v11, v41
    v_mfma_f32_16x16x32_bf16 v[68:71], v[204:207], v[120:123], v[68:71]
    v_mul_f32 v42, v11, v42
    v_mul_f32 v43, v11, v43
    s_waitcnt lgkmcnt(4)
    v_mfma_f32_16x16x32_bf16 v[56:59], v[208:211], v[124:127], v[56:59]
    ds_read_b128 v[120:123], v6 offset:6144
    v_mul_f32 v44, v11, v44
    v_mul_f32 v45, v11, v45
    v_mfma_f32_16x16x32_bf16 v[60:63], v[212:215], v[124:127], v[60:63]
    v_mul_f32 v46, v11, v46
    v_mul_f32 v47, v11, v47
    v_mfma_f32_16x16x32_bf16 v[64:67], v[216:219], v[124:127], v[64:67]
    v_cvt_pk_bf16_f32 v40, v40, v41
    v_cvt_pk_bf16_f32 v41, v42, v43
    v_mfma_f32_16x16x32_bf16 v[68:71], v[220:223], v[124:127], v[68:71]
    v_cvt_pk_bf16_f32 v42, v44, v45
    v_cvt_pk_bf16_f32 v43, v46, v47
    s_waitcnt lgkmcnt(4)
    v_mfma_f32_16x16x32_bf16 v[56:59], v[224:227], v[104:107], v[56:59]
    ds_read_b128 v[124:127], v7 offset:6144
    buffer_store_dwordx4 v[40:43], v17, s[48:51], s26 offen offset:2048 sc1
    v_mfma_f32_16x16x32_bf16 v[60:63], v[228:231], v[104:107], v[60:63]
    v_mul_f32 v48, v11, v48
    v_mul_f32 v49, v11, v49
    v_mfma_f32_16x16x32_bf16 v[64:67], v[232:235], v[104:107], v[64:67]
    v_mul_f32 v50, v11, v50
    v_mul_f32 v51, v11, v51
    v_mfma_f32_16x16x32_bf16 v[68:71], v[236:239], v[104:107], v[68:71]
    v_mul_f32 v52, v11, v52
    v_mul_f32 v53, v11, v53
    s_waitcnt lgkmcnt(4)
    v_mfma_f32_16x16x32_bf16 v[56:59], v[240:243], v[108:111], v[56:59]
    ds_read_b128 v[104:107], v6 offset:36864
    v_mul_f32 v54, v11, v54
    v_mul_f32 v55, v11, v55
    v_mfma_f32_16x16x32_bf16 v[60:63], v[244:247], v[108:111], v[60:63]
    v_cvt_pk_bf16_f32 v48, v48, v49
    v_cvt_pk_bf16_f32 v49, v50, v51
    v_mfma_f32_16x16x32_bf16 v[64:67], v[248:251], v[108:111], v[64:67]
    v_cvt_pk_bf16_f32 v50, v52, v53
    v_cvt_pk_bf16_f32 v51, v54, v55
    v_mfma_f32_16x16x32_bf16 v[68:71], v[252:255], v[108:111], v[68:71]
    buffer_store_dwordx4 v[48:51], v17, s[48:51], s26 offen offset:3072 sc1
    s_waitcnt lgkmcnt(4)
    v_mfma_f32_16x16x32_bf16 v[72:75], v[192:195], v[112:115], v[72:75]
    ds_read_b128 v[108:111], v7 offset:36864
    v_mfma_f32_16x16x32_bf16 v[76:79], v[196:199], v[112:115], v[76:79]
    v_mfma_f32_16x16x32_bf16 v[80:83], v[200:203], v[112:115], v[80:83]
    v_mul_f32 v56, v12, v56
    v_mul_f32 v57, v12, v57
    v_mfma_f32_16x16x32_bf16 v[84:87], v[204:207], v[112:115], v[84:87]
    v_mul_f32 v58, v12, v58
    v_mul_f32 v59, v12, v59
    s_waitcnt lgkmcnt(4)
    v_mfma_f32_16x16x32_bf16 v[72:75], v[208:211], v[116:119], v[72:75]
    ds_read_b128 v[112:115], v6 offset:38912
    v_mul_f32 v60, v12, v60
    v_mul_f32 v61, v12, v61
    v_mfma_f32_16x16x32_bf16 v[76:79], v[212:215], v[116:119], v[76:79]
    v_mul_f32 v62, v12, v62
    v_mul_f32 v63, v12, v63
    v_mfma_f32_16x16x32_bf16 v[80:83], v[216:219], v[116:119], v[80:83]
    v_cvt_pk_bf16_f32 v56, v56, v57
    v_cvt_pk_bf16_f32 v57, v58, v59
    v_mfma_f32_16x16x32_bf16 v[84:87], v[220:223], v[116:119], v[84:87]
    v_cvt_pk_bf16_f32 v58, v60, v61
    v_cvt_pk_bf16_f32 v59, v62, v63
    s_waitcnt lgkmcnt(4)
    v_mfma_f32_16x16x32_bf16 v[72:75], v[224:227], v[120:123], v[72:75]
    ds_read_b128 v[116:119], v7 offset:38912
    buffer_store_dwordx4 v[56:59], v17, s[48:51], s27 offen offset:0 sc1
    v_mfma_f32_16x16x32_bf16 v[76:79], v[228:231], v[120:123], v[76:79]
    v_mul_f32 v64, v12, v64
    v_mul_f32 v65, v12, v65
    v_mfma_f32_16x16x32_bf16 v[80:83], v[232:235], v[120:123], v[80:83]
    v_mul_f32 v66, v12, v66
    v_mul_f32 v67, v12, v67
    v_mfma_f32_16x16x32_bf16 v[84:87], v[236:239], v[120:123], v[84:87]
    v_mul_f32 v68, v12, v68
    v_mul_f32 v69, v12, v69
    s_waitcnt lgkmcnt(4)
    v_mfma_f32_16x16x32_bf16 v[72:75], v[240:243], v[124:127], v[72:75]
    v_mul_f32 v70, v12, v70
    v_mul_f32 v71, v12, v71
    v_mfma_f32_16x16x32_bf16 v[76:79], v[244:247], v[124:127], v[76:79]
    v_cvt_pk_bf16_f32 v64, v64, v65
    v_cvt_pk_bf16_f32 v65, v66, v67
    v_mfma_f32_16x16x32_bf16 v[80:83], v[248:251], v[124:127], v[80:83]
    v_cvt_pk_bf16_f32 v66, v68, v69
    v_cvt_pk_bf16_f32 v67, v70, v71
    v_mfma_f32_16x16x32_bf16 v[84:87], v[252:255], v[124:127], v[84:87]
    buffer_store_dwordx4 v[64:67], v17, s[48:51], s27 offen offset:1024 sc1
    s_waitcnt lgkmcnt(3)
    v_mfma_f32_16x16x32_bf16 v[88:91], v[192:195], v[104:107], v[88:91]
    v_mfma_f32_16x16x32_bf16 v[92:95], v[196:199], v[104:107], v[92:95]
    v_mfma_f32_16x16x32_bf16 v[96:99], v[200:203], v[104:107], v[96:99]
    v_mul_f32 v72, v13, v72
    v_mul_f32 v73, v13, v73
    v_mfma_f32_16x16x32_bf16 v[100:103], v[204:207], v[104:107], v[100:103]
    v_mul_f32 v74, v13, v74
    v_mul_f32 v75, v13, v75
    s_waitcnt lgkmcnt(2)
    v_mfma_f32_16x16x32_bf16 v[88:91], v[208:211], v[108:111], v[88:91]
    v_mul_f32 v76, v13, v76
    v_mul_f32 v77, v13, v77
    v_mfma_f32_16x16x32_bf16 v[92:95], v[212:215], v[108:111], v[92:95]
    v_mul_f32 v78, v13, v78
    v_mul_f32 v79, v13, v79
    v_mfma_f32_16x16x32_bf16 v[96:99], v[216:219], v[108:111], v[96:99]
    v_cvt_pk_bf16_f32 v72, v72, v73
    v_cvt_pk_bf16_f32 v73, v74, v75
    v_mfma_f32_16x16x32_bf16 v[100:103], v[220:223], v[108:111], v[100:103]
    v_cvt_pk_bf16_f32 v74, v76, v77
    v_cvt_pk_bf16_f32 v75, v78, v79
    s_waitcnt lgkmcnt(1)
    v_mfma_f32_16x16x32_bf16 v[88:91], v[224:227], v[112:115], v[88:91]
    buffer_store_dwordx4 v[72:75], v17, s[48:51], s27 offen offset:2048 sc1
    v_mfma_f32_16x16x32_bf16 v[92:95], v[228:231], v[112:115], v[92:95]
    v_mul_f32 v80, v13, v80
    v_mul_f32 v81, v13, v81
    v_mfma_f32_16x16x32_bf16 v[96:99], v[232:235], v[112:115], v[96:99]
    v_mul_f32 v82, v13, v82
    v_mul_f32 v83, v13, v83
    v_mfma_f32_16x16x32_bf16 v[100:103], v[236:239], v[112:115], v[100:103]
    v_mul_f32 v84, v13, v84
    v_mul_f32 v85, v13, v85
    s_waitcnt lgkmcnt(0)
    v_mfma_f32_16x16x32_bf16 v[88:91], v[240:243], v[116:119], v[88:91]
    v_mul_f32 v86, v13, v86
    v_mul_f32 v87, v13, v87
    v_mfma_f32_16x16x32_bf16 v[92:95], v[244:247], v[116:119], v[92:95]
    v_cvt_pk_bf16_f32 v80, v80, v81
    v_cvt_pk_bf16_f32 v81, v82, v83
    v_mfma_f32_16x16x32_bf16 v[96:99], v[248:251], v[116:119], v[96:99]
    v_cvt_pk_bf16_f32 v82, v84, v85
    v_cvt_pk_bf16_f32 v83, v86, v87
    v_mfma_f32_16x16x32_bf16 v[100:103], v[252:255], v[116:119], v[100:103]
    buffer_store_dwordx4 v[80:83], v17, s[48:51], s27 offen offset:3072 sc1
    v_mul_f32 v88, v14, v88
    v_mul_f32 v89, v14, v89
    v_mul_f32 v90, v14, v90
    v_mul_f32 v91, v14, v91
    v_mul_f32 v92, v14, v92
    v_mul_f32 v93, v14, v93
    v_mul_f32 v94, v14, v94
    v_mul_f32 v95, v14, v95
    v_cvt_pk_bf16_f32 v88, v88, v89
    v_cvt_pk_bf16_f32 v89, v90, v91
    v_cvt_pk_bf16_f32 v90, v92, v93
    v_cvt_pk_bf16_f32 v91, v94, v95
    buffer_store_dwordx4 v[88:91], v17, s[48:51], s28 offen offset:0 sc1
    v_mul_f32 v96, v14, v96
    v_mul_f32 v97, v14, v97
    v_mul_f32 v98, v14, v98
    v_mul_f32 v99, v14, v99
    v_mul_f32 v100, v14, v100
    v_mul_f32 v101, v14, v101
    v_mul_f32 v102, v14, v102
    v_mul_f32 v103, v14, v103
    v_cvt_pk_bf16_f32 v96, v96, v97
    v_cvt_pk_bf16_f32 v97, v98, v99
    v_cvt_pk_bf16_f32 v98, v100, v101
    v_cvt_pk_bf16_f32 v99, v102, v103
    buffer_store_dwordx4 v[96:99], v17, s[48:51], s28 offen offset:1024 sc1
L_opub:
    s_lshr_b32 s26, s20, 2
    s_lshl_b32 s27, s26, 2
    s_add_u32 s27, s27, 159752
    v_mov_b32 v6, s27
    v_mov_b32 v7, 159748
    v_mov_b32 v3, 1
    v_cmp_eq_u32 vcc, 0, v1
    s_nop 1
    v_cndmask_b32 v4, 0, v3, vcc
    v_lshlrev_b32 v2, 8, v1
    s_sub_u32 s28, 3, s26
    s_lshl_b32 s26, s26, 6
    s_lshl_b32 s27, s24, 2
    s_add_u32 s26, s26, s27
    s_waitcnt vmcnt(0)
    ds_add_rtn_u32 v4, v6, v4
    s_waitcnt lgkmcnt(0)
    v_readfirstlane_b32 s27, v4
    s_nop 0
    s_cmp_eq_u32 s27, s28
    s_cbranch_scc0 L_nopub
    buffer_store_dword v3, v2, s[92:95], s26 offen sc1
L_nopub:
    s_cmp_ge_u32 s20, 5
    s_cbranch_scc1 L_fin
    s_mul_i32 s26, s25, 1146880
    s_add_u32 s36, s18, s26
    s_addc_u32 s37, s19, 0
    s_mov_b32 s38, 1146880
    s_mov_b32 s39, 0x20000
    s_mov_b32 s40, s14
    s_mov_b32 s41, s15
    s_mov_b32 s42, 1146880
    s_mov_b32 s43, 0x20000
    v_and_b32 v3, 15, v1
    v_mul_u32_u24 v3, 896, v3
    v_lshrrev_b32 v4, 4, v1
    v_lshl_add_u32 v3, v4, 3, v3
    v_lshlrev_b32 v2, 4, v1
    s_add_u32 s59, s58, 0
    s_lshl_b32 s59, s59, 4
    s_add_u32 s59, s59, s24
    s_mul_i32 s60, s59, 205
    s_lshr_b32 s60, s60, 11
    s_mul_i32 s61, s60, 10
    s_sub_u32 s61, s59, s61
    s_lshr_b32 s26, s61, 1
    s_lshl_b32 s26, s26, 4
    s_mul_i32 s27, s25, 80
    s_add_u32 s27, s27, s26
    s_mul_i32 s27, s27, 896
    s_lshl_b32 s60, s60, 7
    s_add_u32 s27, s27, s60
    s_and_b32 s61, s61, 1
    s_lshl_b32 s61, s61, 6
    s_add_u32 s27, s27, s61
    s_lshl_b32 s26, s59, 10
    s_cmp_ge_u32 s59, 40
    s_cselect_b32 s65, 16, 0
    s_cmp_ge_u32 s59, 70
    s_cselect_b32 s26, 0x40000000, s26
    s_cselect_b32 s27, 0x40000000, s27
    v_add_u32 v2, s26, v2
    v_add_u32 v3, s27, v3
    s_mov_b32 s63, 0
    s_mov_b32 s67, 0
    s_mov_b32 s27, 0x400000
    v_mov_b32 v16, 0
    v_mov_b32 v17, 0
    v_mov_b32 v18, 0
    v_mov_b32 v19, 0
    v_mov_b32 v20, 0
    v_mov_b32 v21, 0
    v_mov_b32 v22, 0
    v_mov_b32 v23, 0
    v_mov_b32 v24, 0
    v_mov_b32 v25, 0
    v_mov_b32 v26, 0
    v_mov_b32 v27, 0
    v_mov_b32 v28, 0
    v_mov_b32 v29, 0
    v_mov_b32 v30, 0
    v_mov_b32 v31, 0
    v_mov_b32 v8, 0x3f80
    v_mov_b32 v9, 0x3f800000
L_rpoll:
    ds_read_b32 v4, v7
    s_waitcnt lgkmcnt(0)
    v_readfirstlane_b32 s28, v4
    s_nop 0
    s_lshr_b32 s64, s28, s65
    s_and_b32 s64, s64, 0xffff
    s_andn2_b32 s64, s64, s63
    s_cbranch_scc0 L_rnone
    s_bitcmp1_b32 s64, 0
    s_cbranch_scc0 L_rskip0
    s_mov_b32 s26, 0
    buffer_load_dwordx4 v[32:35], v2, s[36:39], s26 offen sc1
L_rskip0:
    s_bitcmp1_b32 s64, 1
    s_cbranch_scc0 L_rskip1
    s_mov_b32 s26, 71680
    buffer_load_dwordx4 v[36:39], v2, s[36:39], s26 offen sc1
L_rskip1:
    s_bitcmp1_b32 s64, 2
    s_cbranch_scc0 L_rskip2
    s_mov_b32 s26, 143360
    buffer_load_dwordx4 v[40:43], v2, s[36:39], s26 offen sc1
L_rskip2:
    s_bitcmp1_b32 s64, 3
    s_cbranch_scc0 L_rskip3
    s_mov_b32 s26, 215040
    buffer_load_dwordx4 v[44:47], v2, s[36:39], s26 offen sc1
L_rskip3:
    s_bitcmp1_b32 s64, 4
    s_cbranch_scc0 L_rskip4
    s_mov_b32 s26, 286720
    buffer_load_dwordx4 v[48:51], v2, s[36:39], s26 offen sc1
L_rskip4:
    s_bitcmp1_b32 s64, 5
    s_cbranch_scc0 L_rskip5
    s_mov_b32 s26, 358400
    buffer_load_dwordx4 v[52:55], v2, s[36:39], s26 offen sc1
L_rskip5:
    s_bitcmp1_b32 s64, 6
    s_cbranch_scc0 L_rskip6
    s_mov_b32 s26, 430080
    buffer_load_dwordx4 v[56:59], v2, s[36:39], s26 offen sc1
L_rskip6:
    s_bitcmp1_b32 s64, 7
    s_cbranch_scc0 L_rskip7
    s_mov_b32 s26, 501760
    buffer_load_dwordx4 v[60:63], v2, s[36:39], s26 offen sc1
L_rskip7:
    s_bitcmp1_b32 s64, 8
    s_cbranch_scc0 L_rskip8
    s_mov_b32 s26, 573440
    buffer_load_dwordx4 v[64:67], v2, s[36:39], s26 offen sc1
L_rskip8:
    s_bitcmp1_b32 s64, 9
    s_cbranch_scc0 L_rskip9
    s_mov_b32 s26, 645120
    buffer_load_dwordx4 v[68:71], v2, s[36:39], s26 offen sc1
L_rskip9:
    s_bitcmp1_b32 s64, 10
    s_cbranch_scc0 L_rskip10
    s_mov_b32 s26, 716800
    buffer_load_dwordx4 v[72:75], v2, s[36:39], s26 offen sc1
L_rskip10:
    s_bitcmp1_b32 s64, 11
    s_cbranch_scc0 L_rskip11
    s_mov_b32 s26, 788480
    buffer_load_dwordx4 v[76:79], v2, s[36:39], s26 offen sc1
L_rskip11:
    s_bitcmp1_b32 s64, 12
    s_cbranch_scc0 L_rskip12
    s_mov_b32 s26, 860160
    buffer_load_dwordx4 v[80:83], v2, s[36:39], s26 offen sc1
L_rskip12:
    s_bitcmp1_b32 s64, 13
    s_cbranch_scc0 L_rskip13
    s_mov_b32 s26, 931840
    buffer_load_dwordx4 v[84:87], v2, s[36:39], s26 offen sc1
L_rskip13:
    s_bitcmp1_b32 s64, 14
    s_cbranch_scc0 L_rskip14
    s_mov_b32 s26, 1003520
    buffer_load_dwordx4 v[88:91], v2, s[36:39], s26 offen sc1
L_rskip14:
    s_bitcmp1_b32 s64, 15
    s_cbranch_scc0 L_rskip15
    s_mov_b32 s26, 1075200
    buffer_load_dwordx4 v[92:95], v2, s[36:39], s26 offen sc1
L_rskip15:
    s_or_b32 s63, s63, s64
    s_cmp_eq_u32 s63, 0xffff
    s_cbranch_scc1 L_rsum
L_rnone:
    s_sleep 1
    s_sub_u32 s27, s27, 1
    s_cmp_lg_u32 s27, 0
    s_cbranch_scc1 L_rpoll
L_rsum:
    s_waitcnt vmcnt(0)
    v_dot2c_f32_bf16 v16, v32, v8
    v_dot2c_f32_bf16 v17, v32, v9
    v_dot2c_f32_bf16 v18, v33, v8
    v_dot2c_f32_bf16 v19, v33, v9
    v_dot2c_f32_bf16 v20, v34, v8
    v_dot2c_f32_bf16 v21, v34, v9
    v_dot2c_f32_bf16 v22, v35, v8
    v_dot2c_f32_bf16 v23, v35, v9
    v_dot2c_f32_bf16 v16, v36, v8
    v_dot2c_f32_bf16 v17, v36, v9
    v_dot2c_f32_bf16 v18, v37, v8
    v_dot2c_f32_bf16 v19, v37, v9
    v_dot2c_f32_bf16 v20, v38, v8
    v_dot2c_f32_bf16 v21, v38, v9
    v_dot2c_f32_bf16 v22, v39, v8
    v_dot2c_f32_bf16 v23, v39, v9
    v_dot2c_f32_bf16 v16, v40, v8
    v_dot2c_f32_bf16 v17, v40, v9
    v_dot2c_f32_bf16 v18, v41, v8
    v_dot2c_f32_bf16 v19, v41, v9
    v_dot2c_f32_bf16 v20, v42, v8
    v_dot2c_f32_bf16 v21, v42, v9
    v_dot2c_f32_bf16 v22, v43, v8
    v_dot2c_f32_bf16 v23, v43, v9
    v_dot2c_f32_bf16 v16, v44, v8
    v_dot2c_f32_bf16 v17, v44, v9
    v_dot2c_f32_bf16 v18, v45, v8
    v_dot2c_f32_bf16 v19, v45, v9
    v_dot2c_f32_bf16 v20, v46, v8
    v_dot2c_f32_bf16 v21, v46, v9
    v_dot2c_f32_bf16 v22, v47, v8
    v_dot2c_f32_bf16 v23, v47, v9
    v_dot2c_f32_bf16 v16, v48, v8
    v_dot2c_f32_bf16 v17, v48, v9
    v_dot2c_f32_bf16 v18, v49, v8
    v_dot2c_f32_bf16 v19, v49, v9
    v_dot2c_f32_bf16 v20, v50, v8
    v_dot2c_f32_bf16 v21, v50, v9
    v_dot2c_f32_bf16 v22, v51, v8
    v_dot2c_f32_bf16 v23, v51, v9
    v_dot2c_f32_bf16 v16, v52, v8
    v_dot2c_f32_bf16 v17, v52, v9
    v_dot2c_f32_bf16 v18, v53, v8
    v_dot2c_f32_bf16 v19, v53, v9
    v_dot2c_f32_bf16 v20, v54, v8
    v_dot2c_f32_bf16 v21, v54, v9
    v_dot2c_f32_bf16 v22, v55, v8
    v_dot2c_f32_bf16 v23, v55, v9
    v_dot2c_f32_bf16 v16, v56, v8
    v_dot2c_f32_bf16 v17, v56, v9
    v_dot2c_f32_bf16 v18, v57, v8
    v_dot2c_f32_bf16 v19, v57, v9
    v_dot2c_f32_bf16 v20, v58, v8
    v_dot2c_f32_bf16 v21, v58, v9
    v_dot2c_f32_bf16 v22, v59, v8
    v_dot2c_f32_bf16 v23, v59, v9
    v_dot2c_f32_bf16 v16, v60, v8
    v_dot2c_f32_bf16 v17, v60, v9
    v_dot2c_f32_bf16 v18, v61, v8
    v_dot2c_f32_bf16 v19, v61, v9
    v_dot2c_f32_bf16 v20, v62, v8
    v_dot2c_f32_bf16 v21, v62, v9
    v_dot2c_f32_bf16 v22, v63, v8
    v_dot2c_f32_bf16 v23, v63, v9
    v_dot2c_f32_bf16 v16, v64, v8
    v_dot2c_f32_bf16 v17, v64, v9
    v_dot2c_f32_bf16 v18, v65, v8
    v_dot2c_f32_bf16 v19, v65, v9
    v_dot2c_f32_bf16 v20, v66, v8
    v_dot2c_f32_bf16 v21, v66, v9
    v_dot2c_f32_bf16 v22, v67, v8
    v_dot2c_f32_bf16 v23, v67, v9
    v_dot2c_f32_bf16 v16, v68, v8
    v_dot2c_f32_bf16 v17, v68, v9
    v_dot2c_f32_bf16 v18, v69, v8
    v_dot2c_f32_bf16 v19, v69, v9
    v_dot2c_f32_bf16 v20, v70, v8
    v_dot2c_f32_bf16 v21, v70, v9
    v_dot2c_f32_bf16 v22, v71, v8
    v_dot2c_f32_bf16 v23, v71, v9
    v_dot2c_f32_bf16 v16, v72, v8
    v_dot2c_f32_bf16 v17, v72, v9
    v_dot2c_f32_bf16 v18, v73, v8
    v_dot2c_f32_bf16 v19, v73, v9
    v_dot2c_f32_bf16 v20, v74, v8
    v_dot2c_f32_bf16 v21, v74, v9
    v_dot2c_f32_bf16 v22, v75, v8
    v_dot2c_f32_bf16 v23, v75, v9
    v_dot2c_f32_bf16 v16, v76, v8
    v_dot2c_f32_bf16 v17, v76, v9
    v_dot2c_f32_bf16 v18, v77, v8
    v_dot2c_f32_bf16 v19, v77, v9
    v_dot2c_f32_bf16 v20, v78, v8
    v_dot2c_f32_bf16 v21, v78, v9
    v_dot2c_f32_bf16 v22, v79, v8
    v_dot2c_f32_bf16 v23, v79, v9
    v_dot2c_f32_bf16 v16, v80, v8
    v_dot2c_f32_bf16 v17, v80, v9
    v_dot2c_f32_bf16 v18, v81, v8
    v_dot2c_f32_bf16 v19, v81, v9
    v_dot2c_f32_bf16 v20, v82, v8
    v_dot2c_f32_bf16 v21, v82, v9
    v_dot2c_f32_bf16 v22, v83, v8
    v_dot2c_f32_bf16 v23, v83, v9
    v_dot2c_f32_bf16 v16, v84, v8
    v_dot2c_f32_bf16 v17, v84, v9
    v_dot2c_f32_bf16 v18, v85, v8
    v_dot2c_f32_bf16 v19, v85, v9
    v_dot2c_f32_bf16 v20, v86, v8
    v_dot2c_f32_bf16 v21, v86, v9
    v_dot2c_f32_bf16 v22, v87, v8
    v_dot2c_f32_bf16 v23, v87, v9
    v_dot2c_f32_bf16 v16, v88, v8
    v_dot2c_f32_bf16 v17, v88, v9
    v_dot2c_f32_bf16 v18, v89, v8
    v_dot2c_f32_bf16 v19, v89, v9
    v_dot2c_f32_bf16 v20, v90, v8
    v_dot2c_f32_bf16 v21, v90, v9
    v_dot2c_f32_bf16 v22, v91, v8
    v_dot2c_f32_bf16 v23, v91, v9
    v_dot2c_f32_bf16 v16, v92, v8
    v_dot2c_f32_bf16 v17, v92, v9
    v_dot2c_f32_bf16 v18, v93, v8
    v_dot2c_f32_bf16 v19, v93, v9
    v_dot2c_f32_bf16 v20, v94, v8
    v_dot2c_f32_bf16 v21, v94, v9
    v_dot2c_f32_bf16 v22, v95, v8
    v_dot2c_f32_bf16 v23, v95, v9
L_rall:
    s_nop 3
    v_cvt_pk_bf16_f32 v32, v16, v17
    v_cvt_pk_bf16_f32 v33, v18, v19
    v_cvt_pk_bf16_f32 v34, v20, v21
    v_cvt_pk_bf16_f32 v35, v22, v23
    buffer_store_dwordx2 v[32:33], v3, s[40:43], 0 offen
    buffer_store_dwordx2 v[34:35], v3, s[40:43], 0 offen offset:32
L_fin:
L_end:
    s_endpgm
L_comm:
    v_mov_b32 v7, 159748
    v_lshlrev_b32 v2, 8, v1
    v_lshlrev_b32 v5, 2, v1
    s_mov_b32 s27, 0x40000
    s_lshl_b32 s26, s25, 4
L_cpoll:
    buffer_load_dword v4, v2, s[84:87], s26 offen sc1
    s_waitcnt vmcnt(0)
    v_readfirstlane_b32 s28, v4
    s_nop 0
    s_cmp_eq_u32 s28, 0xffff
    s_cbranch_scc1 L_cdone
    s_sub_u32 s27, s27, 1
    s_cmp_lg_u32 s27, 0
    s_cbranch_scc1 L_cpoll
    s_branch L_fin
L_cdone:
L_cw:
    s_sleep 1
    ds_read_b64 v[8:9], v7 offset:4
    s_waitcnt lgkmcnt(0)
    v_add_u32 v8, v8, v9
    s_nop 0
    v_readfirstlane_b32 s28, v8
    s_nop 0
    s_cmp_ge_u32 s28, 7
    s_cbranch_scc0 L_cw
L_poll:
    buffer_load_dword v4, v5, s[92:95], 0 offen sc1
    s_waitcnt vmcnt(0)
    v_cmp_eq_u32 vcc, 1, v4
    s_nop 0
    s_mov_b32 s28, vcc_lo
    v_mov_b32 v4, s28
    ds_write_b32 v7, v4
    s_waitcnt lgkmcnt(0)
    s_cmp_eq_u32 s28, -1
    s_cbranch_scc1 L_fin
    s_sub_u32 s27, s27, 1
    s_cmp_gt_i32 s27, 0
    s_cbranch_scc1 L_poll
    s_branch L_fin
L_ppf:
    v_lshlrev_b32 v18, 7, v1
    v_cmp_gt_u32 vcc, 28, v1
    v_mov_b32 v17, 0x7fffffff
    s_nop 0
    v_cndmask_b32 v18, v17, v18, vcc
    buffer_load_dword v17, v18, s[44:47], s82 offen
    s_branch L_ppfj
L_psync_even:
    s_barrier
    s_mov_b32 s81, 1
    s_branch L_psyncj_even
L_psync_odd:
    s_barrier
    s_mov_b32 s81, 1
    s_branch L_psyncj_odd
L_psync_d14:
    s_barrier
    s_mov_b32 s81, 1
    s_branch L_psyncj_d14
L_prare_even:
    ds_read_b128 v[12:15], v11 offset:512
    ds_read_b32 v16, v11 offset:528
    s_waitcnt lgkmcnt(0)
    s_nop 9
    v_mul_f32 v176, v176, v12
    v_mul_f32 v177, v177, v12
    v_mul_f32 v178, v178, v12
    v_mul_f32 v179, v179, v12
    v_mul_f32 v180, v180, v13
    v_mul_f32 v181, v181, v13
    v_mul_f32 v182, v182, v13
    v_mul_f32 v183, v183, v13
    v_mul_f32 v184, v184, v14
    v_mul_f32 v185, v185, v14
    v_mul_f32 v186, v186, v14
    v_mul_f32 v187, v187, v14
    v_mul_f32 v188, v188, v15
    v_mul_f32 v189, v189, v15
    v_mul_f32 v190, v190, v15
    v_mul_f32 v191, v191, v15
    v_mul_f32 v192, v192, v16
    v_mul_f32 v193, v193, v16
    v_mul_f32 v194, v194, v16
    v_mul_f32 v195, v195, v16
    v_mul_f32 v196, v196, v12
    v_mul_f32 v197, v197, v12
    v_mul_f32 v198, v198, v12
    v_mul_f32 v199, v199, v12
    v_mul_f32 v200, v200, v13
    v_mul_f32 v201, v201, v13
    v_mul_f32 v202, v202, v13
    v_mul_f32 v203, v203, v13
    v_mul_f32 v204, v204, v14
    v_mul_f32 v205, v205, v14
    v_mul_f32 v206, v206, v14
    v_mul_f32 v207, v207, v14
    v_mul_f32 v208, v208, v15
    v_mul_f32 v209, v209, v15
    v_mul_f32 v210, v210, v15
    v_mul_f32 v211, v211, v15
    v_mul_f32 v212, v212, v16
    v_mul_f32 v213, v213, v16
    v_mul_f32 v214, v214, v16
    v_mul_f32 v215, v215, v16
    v_mul_f32 v216, v216, v12
    v_mul_f32 v217, v217, v12
    v_mul_f32 v218, v218, v12
    v_mul_f32 v219, v219, v12
    v_mul_f32 v220, v220, v13
    v_mul_f32 v221, v221, v13
    v_mul_f32 v222, v222, v13
    v_mul_f32 v223, v223, v13
    v_mul_f32 v224, v224, v14
    v_mul_f32 v225, v225, v14
    v_mul_f32 v226, v226, v14
    v_mul_f32 v227, v227, v14
    v_mul_f32 v228, v228, v15
    v_mul_f32 v229, v229, v15
    v_mul_f32 v230, v230, v15
    v_mul_f32 v231, v231, v15
    v_mul_f32 v232, v232, v16
    v_mul_f32 v233, v233, v16
    v_mul_f32 v234, v234, v16
    v_mul_f32 v235, v235, v16
    v_mul_f32 v236, v236, v12
    v_mul_f32 v237, v237, v12
    v_mul_f32 v238, v238, v12
    v_mul_f32 v239, v239, v12
    v_mul_f32 v240, v240, v13
    v_mul_f32 v241, v241, v13
    v_mul_f32 v242, v242, v13
    v_mul_f32 v243, v243, v13
    v_mul_f32 v244, v244, v14
    v_mul_f32 v245, v245, v14
    v_mul_f32 v246, v246, v14
    v_mul_f32 v247, v247, v14
    v_mul_f32 v248, v248, v15
    v_mul_f32 v249, v249, v15
    v_mul_f32 v250, v250, v15
    v_mul_f32 v251, v251, v15
    v_mul_f32 v252, v252, v16
    v_mul_f32 v253, v253, v16
    v_mul_f32 v254, v254, v16
    v_mul_f32 v255, v255, v16
    s_nop 3
    s_branch L_pjoin_even
L_prare_odd:
    ds_read_b128 v[12:15], v11 offset:1024
    ds_read_b32 v16, v11 offset:1040
    s_waitcnt lgkmcnt(0)
    s_nop 9
    v_mul_f32 v176, v176, v12
    v_mul_f32 v177, v177, v12
    v_mul_f32 v178, v178, v12
    v_mul_f32 v179, v179, v12
    v_mul_f32 v180, v180, v13
    v_mul_f32 v181, v181, v13
    v_mul_f32 v182, v182, v13
    v_mul_f32 v183, v183, v13
    v_mul_f32 v184, v184, v14
    v_mul_f32 v185, v185, v14
    v_mul_f32 v186, v186, v14
    v_mul_f32 v187, v187, v14
    v_mul_f32 v188, v188, v15
    v_mul_f32 v189, v189, v15
    v_mul_f32 v190, v190, v15
    v_mul_f32 v191, v191, v15
    v_mul_f32 v192, v192, v16
    v_mul_f32 v193, v193, v16
    v_mul_f32 v194, v194, v16
    v_mul_f32 v195, v195, v16
    v_mul_f32 v196, v196, v12
    v_mul_f32 v197, v197, v12
    v_mul_f32 v198, v198, v12
    v_mul_f32 v199, v199, v12
    v_mul_f32 v200, v200, v13
    v_mul_f32 v201, v201, v13
    v_mul_f32 v202, v202, v13
    v_mul_f32 v203, v203, v13
    v_mul_f32 v204, v204, v14
    v_mul_f32 v205, v205, v14
    v_mul_f32 v206, v206, v14
    v_mul_f32 v207, v207, v14
    v_mul_f32 v208, v208, v15
    v_mul_f32 v209, v209, v15
    v_mul_f32 v210, v210, v15
    v_mul_f32 v211, v211, v15
    v_mul_f32 v212, v212, v16
    v_mul_f32 v213, v213, v16
    v_mul_f32 v214, v214, v16
    v_mul_f32 v215, v215, v16
    v_mul_f32 v216, v216, v12
    v_mul_f32 v217, v217, v12
    v_mul_f32 v218, v218, v12
    v_mul_f32 v219, v219, v12
    v_mul_f32 v220, v220, v13
    v_mul_f32 v221, v221, v13
    v_mul_f32 v222, v222, v13
    v_mul_f32 v223, v223, v13
    v_mul_f32 v224, v224, v14
    v_mul_f32 v225, v225, v14
    v_mul_f32 v226, v226, v14
    v_mul_f32 v227, v227, v14
    v_mul_f32 v228, v228, v15
    v_mul_f32 v229, v229, v15
    v_mul_f32 v230, v230, v15
    v_mul_f32 v231, v231, v15
    v_mul_f32 v232, v232, v16
    v_mul_f32 v233, v233, v16
    v_mul_f32 v234, v234, v16
    v_mul_f32 v235, v235, v16
    v_mul_f32 v236, v236, v12
    v_mul_f32 v237, v237, v12
    v_mul_f32 v238, v238, v12
    v_mul_f32 v239, v239, v12
    v_mul_f32 v240, v240, v13
    v_mul_f32 v241, v241, v13
    v_mul_f32 v242, v242, v13
    v_mul_f32 v243, v243, v13
    v_mul_f32 v244, v244, v14
    v_mul_f32 v245, v245, v14
    v_mul_f32 v246, v246, v14
    v_mul_f32 v247, v247, v14
    v_mul_f32 v248, v248, v15
    v_mul_f32 v249, v249, v15
    v_mul_f32 v250, v250, v15
    v_mul_f32 v251, v251, v15
    v_mul_f32 v252, v252, v16
    v_mul_f32 v253, v253, v16
    v_mul_f32 v254, v254, v16
    v_mul_f32 v255, v255, v16
    s_nop 3
    s_branch L_pjoin_odd
L_prare_d14:
    ds_read_b128 v[12:15], v11 offset:512
    ds_read_b32 v16, v11 offset:528
    s_waitcnt lgkmcnt(0)
    s_nop 9
    v_mul_f32 v176, v176, v12
    v_mul_f32 v177, v177, v12
    v_mul_f32 v178, v178, v12
    v_mul_f32 v179, v179, v12
    v_mul_f32 v180, v180, v13
    v_mul_f32 v181, v181, v13
    v_mul_f32 v182, v182, v13
    v_mul_f32 v183, v183, v13
    v_mul_f32 v184, v184, v14
    v_mul_f32 v185, v185, v14
    v_mul_f32 v186, v186, v14
    v_mul_f32 v187, v187, v14
    v_mul_f32 v188, v188, v15
    v_mul_f32 v189, v189, v15
    v_mul_f32 v190, v190, v15
    v_mul_f32 v191, v191, v15
    v_mul_f32 v192, v192, v16
    v_mul_f32 v193, v193, v16
    v_mul_f32 v194, v194, v16
    v_mul_f32 v195, v195, v16
    v_mul_f32 v196, v196, v12
    v_mul_f32 v197, v197, v12
    v_mul_f32 v198, v198, v12
    v_mul_f32 v199, v199, v12
    v_mul_f32 v200, v200, v13
    v_mul_f32 v201, v201, v13
    v_mul_f32 v202, v202, v13
    v_mul_f32 v203, v203, v13
    v_mul_f32 v204, v204, v14
    v_mul_f32 v205, v205, v14
    v_mul_f32 v206, v206, v14
    v_mul_f32 v207, v207, v14
    v_mul_f32 v208, v208, v15
    v_mul_f32 v209, v209, v15
    v_mul_f32 v210, v210, v15
    v_mul_f32 v211, v211, v15
    v_mul_f32 v212, v212, v16
    v_mul_f32 v213, v213, v16
    v_mul_f32 v214, v214, v16
    v_mul_f32 v215, v215, v16
    v_mul_f32 v216, v216, v12
    v_mul_f32 v217, v217, v12
    v_mul_f32 v218, v218, v12
    v_mul_f32 v219, v219, v12
    v_mul_f32 v220, v220, v13
    v_mul_f32 v221, v221, v13
    v_mul_f32 v222, v222, v13
    v_mul_f32 v223, v223, v13
    v_mul_f32 v224, v224, v14
    v_mul_f32 v225, v225, v14
    v_mul_f32 v226, v226, v14
    v_mul_f32 v227, v227, v14
    v_mul_f32 v228, v228, v15
    v_mul_f32 v229, v229, v15
    v_mul_f32 v230, v230, v15
    v_mul_f32 v231, v231, v15
    v_mul_f32 v232, v232, v16
    v_mul_f32 v233, v233, v16
    v_mul_f32 v234, v234, v16
    v_mul_f32 v235, v235, v16
    v_mul_f32 v236, v236, v12
    v_mul_f32 v237, v237, v12
    v_mul_f32 v238, v238, v12
    v_mul_f32 v239, v239, v12
    v_mul_f32 v240, v240, v13
    v_mul_f32 v241, v241, v13
    v_mul_f32 v242, v242, v13
    v_mul_f32 v243, v243, v13
    v_mul_f32 v244, v244, v14
    v_mul_f32 v245, v245, v14
    v_mul_f32 v246, v246, v14
    v_mul_f32 v247, v247, v14
    v_mul_f32 v248, v248, v15
    v_mul_f32 v249, v249, v15
    v_mul_f32 v250, v250, v15
    v_mul_f32 v251, v251, v15
    v_mul_f32 v252, v252, v16
    v_mul_f32 v253, v253, v16
    v_mul_f32 v254, v254, v16
    v_mul_f32 v255, v255, v16
    s_nop 3
    s_branch L_pjoin_d14
L_prare_d15:
    ds_read_b128 v[12:15], v11 offset:1024
    ds_read_b32 v16, v11 offset:1040
    s_waitcnt lgkmcnt(0)
    s_nop 9
    v_mul_f32 v176, v176, v12
    v_mul_f32 v177, v177, v12
    v_mul_f32 v178, v178, v12
    v_mul_f32 v179, v179, v12
    v_mul_f32 v180, v180, v13
    v_mul_f32 v181, v181, v13
    v_mul_f32 v182, v182, v13
    v_mul_f32 v183, v183, v13
    v_mul_f32 v184, v184, v14
    v_mul_f32 v185, v185, v14
    v_mul_f32 v186, v186, v14
    v_mul_f32 v187, v187, v14
    v_mul_f32 v188, v188, v15
    v_mul_f32 v189, v189, v15
    v_mul_f32 v190, v190, v15
    v_mul_f32 v191, v191, v15
    v_mul_f32 v192, v192, v16
    v_mul_f32 v193, v193, v16
    v_mul_f32 v194, v194, v16
    v_mul_f32 v195, v195, v16
    v_mul_f32 v196, v196, v12
    v_mul_f32 v197, v197, v12
    v_mul_f32 v198, v198, v12
    v_mul_f32 v199, v199, v12
    v_mul_f32 v200, v200, v13
    v_mul_f32 v201, v201, v13
    v_mul_f32 v202, v202, v13
    v_mul_f32 v203, v203, v13
    v_mul_f32 v204, v204, v14
    v_mul_f32 v205, v205, v14
    v_mul_f32 v206, v206, v14
    v_mul_f32 v207, v207, v14
    v_mul_f32 v208, v208, v15
    v_mul_f32 v209, v209, v15
    v_mul_f32 v210, v210, v15
    v_mul_f32 v211, v211, v15
    v_mul_f32 v212, v212, v16
    v_mul_f32 v213, v213, v16
    v_mul_f32 v214, v214, v16
    v_mul_f32 v215, v215, v16
    v_mul_f32 v216, v216, v12
    v_mul_f32 v217, v217, v12
    v_mul_f32 v218, v218, v12
    v_mul_f32 v219, v219, v12
    v_mul_f32 v220, v220, v13
    v_mul_f32 v221, v221, v13
    v_mul_f32 v222, v222, v13
    v_mul_f32 v223, v223, v13
    v_mul_f32 v224, v224, v14
    v_mul_f32 v225, v225, v14
    v_mul_f32 v226, v226, v14
    v_mul_f32 v227, v227, v14
    v_mul_f32 v228, v228, v15
    v_mul_f32 v229, v229, v15
    v_mul_f32 v230, v230, v15
    v_mul_f32 v231, v231, v15
    v_mul_f32 v232, v232, v16
    v_mul_f32 v233, v233, v16
    v_mul_f32 v234, v234, v16
    v_mul_f32 v235, v235, v16
    v_mul_f32 v236, v236, v12
    v_mul_f32 v237, v237, v12
    v_mul_f32 v238, v238, v12
    v_mul_f32 v239, v239, v12
    v_mul_f32 v240, v240, v13
    v_mul_f32 v241, v241, v13
    v_mul_f32 v242, v242, v13
    v_mul_f32 v243, v243, v13
    v_mul_f32 v244, v244, v14
    v_mul_f32 v245, v245, v14
    v_mul_f32 v246, v246, v14
    v_mul_f32 v247, v247, v14
    v_mul_f32 v248, v248, v15
    v_mul_f32 v249, v249, v15
    v_mul_f32 v250, v250, v15
    v_mul_f32 v251, v251, v15
    v_mul_f32 v252, v252, v16
    v_mul_f32 v253, v253, v16
    v_mul_f32 v254, v254, v16
    v_mul_f32 v255, v255, v16
    s_nop 3
    s_branch L_pjoin_d15
L_code_end:
.section .rodata,"a"
.p2align 6
.amdhsa_kernel standalone__gqa_block_cached__near_ridge_kernel
  .amdhsa_next_free_vgpr 256
  .amdhsa_next_free_sgpr 100
  .amdhsa_accum_offset 256
  .amdhsa_group_segment_fixed_size 0
  .amdhsa_kernarg_size 64
  .amdhsa_user_sgpr_count 2
  .amdhsa_user_sgpr_kernarg_segment_ptr 1
  .amdhsa_system_sgpr_workgroup_id_x 1
.end_amdhsa_kernel
```
